```python
import torch

def _softmax(x, axis=-1):
    return torch.softmax(x, dim=axis)
def _gelu(x):
    return torch.nn.functional.gelu(x, approximate="tanh")
def _silu(x):
    return torch.nn.functional.silu(x)
def _sigmoid(x):
    return torch.sigmoid(x)
def _layernorm(x, axis=-1, eps=1e-5):
    m = x.mean(dim=axis, keepdim=True)
    v = x.var(dim=axis, keepdim=True, unbiased=False)
    return (x - m) / torch.sqrt(v + eps)
def _scatter_add(tgt, idx, src, axis=0):
    return tgt.clone().index_add_(axis, idx, src)
def _segment_sum(src, seg, n):
    out = torch.zeros((n,) + src.shape[1:], dtype=src.dtype)
    return out.index_add_(0, seg, src)
def _pad(x, pw):
    flat = tuple(v for pair in reversed(pw) for v in pair)
    return torch.nn.functional.pad(x, flat)

kernel_name = 'parallel_sum__ssm_conv_s4__glu_gated_glu__prompt'

def setup_inputs():

    _w = (lambda a: (lambda t: t.to(torch.bfloat16) if t.is_floating_point() else t)(torch.as_tensor(a)))
    def _A_setup():
        B, L, D, N = 1, 2048, 448, 256
        A_re = -(lambda _x: torch.exp(torch.as_tensor(_x)))((lambda *s: torch.randn(*s, dtype=torch.bfloat16) * 6.4)(D, N))
        A_im = torch.pi * (lambda *s: torch.randn(*s, dtype=torch.bfloat16) * 0.1)(D, N)
        B_re = (lambda *s: torch.randn(*s, dtype=torch.bfloat16) * 0.2)(D, N)
        B_im = (lambda *s: torch.randn(*s, dtype=torch.bfloat16) * 0.2)(D, N)
        C_re = (lambda *s: torch.randn(*s, dtype=torch.bfloat16) * 0.2)(D, N)
        C_im = (lambda *s: torch.randn(*s, dtype=torch.bfloat16) * 0.2)(D, N)
        log_dt = (lambda *s: torch.randn(*s, dtype=torch.bfloat16) * 0.1)(D) * 0.5 - 4.0
        Dskip = (lambda *s: torch.randn(*s, dtype=torch.bfloat16) * 0.1)(D)
        return {
            "u": _w((lambda *s: torch.randn(*s, dtype=torch.bfloat16) * 0.05)(B, L, D)),
            "A_re": _w(A_re),
            "A_im": _w(A_im),
            "B_re": _w(B_re),
            "B_im": _w(B_im),
            "C_re": _w(C_re),
            "C_im": _w(C_im),
            "log_dt": _w(log_dt),
            "Dskip": _w(Dskip),
        }
    _A_in = _A_setup()

    def _B_setup():
        B, S, D, F = 1, 2048, 448, 1792
        return {
            "x": _w((lambda *s: torch.randn(*s, dtype=torch.bfloat16) * 0.05)(B, S, D)),
            "w_gate": _w((lambda *s: torch.randn(*s, dtype=torch.bfloat16) * 0.05)(D, F)),
            "w_up": _w((lambda *s: torch.randn(*s, dtype=torch.bfloat16) * 0.05)(D, F)),
            "w_down": _w((lambda *s: torch.randn(*s, dtype=torch.bfloat16) * 0.05)(F, D)),
        }
    _B_in = _B_setup()

    return {
        "A_u": _A_in["u"],
        "A_A_re": _A_in["A_re"],
        "A_A_im": _A_in["A_im"],
        "A_B_re": _A_in["B_re"],
        "A_B_im": _A_in["B_im"],
        "A_C_re": _A_in["C_re"],
        "A_C_im": _A_in["C_im"],
        "A_log_dt": _A_in["log_dt"],
        "A_Dskip": _A_in["Dskip"],
        "B_x": _B_in["x"],
        "B_w_gate": _B_in["w_gate"],
        "B_w_up": _B_in["w_up"],
        "B_w_down": _B_in["w_down"],
    }

def reference(A_u, A_A_re, A_A_im, A_B_re, A_B_im, A_C_re, A_C_im, A_log_dt, A_Dskip, B_x, B_w_gate, B_w_up, B_w_down):
    def _A_ref(u, A_re, A_im, B_re, B_im, C_re, C_im, log_dt, Dskip):
        Bsz, L, D = u.shape
        dt = torch.exp(log_dt)[:, None]
        A = A_re + 1j * A_im
        Bc = B_re + 1j * B_im
        Cc = C_re + 1j * C_im
        logdA = dt * A
        dB = dt * Bc
        l = (lambda x, dt: x.to(dt))(torch.arange(L), A_re.dtype)
        P = torch.exp(logdA[:, :, None] * l[None, None, :])
        K = torch.einsum("dn,dnl,dn->dl", Cc, P, dB).real
        L2 = 2 * L
        Kp = _pad(K, ((0, 0), (0, L)))
        up = (lambda x, *d: x.permute(*d))(u, 0, 2, 1)
        up = _pad(up, ((0, 0), (0, 0), (0, L)))
        Kf = (lambda x, axes=(-2,-1): torch.fft.rfft2(x.float(), dim=axes))(Kp[:, None, :], axes=(-2, -1))
        Uf = (lambda x, axes=(-2,-1): torch.fft.rfft2(x.float(), dim=axes))(up[:, :, None, :], axes=(-2, -1))
        Yf = Uf * Kf[None, :, :, :]
        y = (lambda x, s, axes=(-2,-1): torch.fft.irfft2(x, s=s, dim=axes).to(torch.bfloat16))(Yf, (1, L2), axes=(-2, -1))[:, :, 0, :L]
        y = (lambda x, *d: x.permute(*d))(y, 0, 2, 1) + u * Dskip[None, None, :]
        return y

    def _B_ref(x, w_gate, w_up, w_down):
        g = torch.einsum("bsd,df->bsf", x, w_gate)
        u = torch.einsum("bsd,df->bsf", x, w_up)
        h = _sigmoid(g) * u
        return torch.einsum("bsf,fd->bsd", h, w_down)

    x = A_u
    xn = _layernorm(x, axis=-1)
    return x + _A_ref(xn, A_A_re, A_A_im, A_B_re, A_B_im, A_C_re, A_C_im, A_log_dt, A_Dskip) + _B_ref(xn, B_w_gate, B_w_up, B_w_down)
```

```asm
; @launch grid=(256,1,1) block=(512,1,1) lds=163840
.amdgcn_target "amdgcn-amd-amdhsa--gfx950"
.text
.globl parallel_sum__ssm_conv_s4__glu_gated_glu__prompt_kernel
.p2align 8
.type parallel_sum__ssm_conv_s4__glu_gated_glu__prompt_kernel,@function
parallel_sum__ssm_conv_s4__glu_gated_glu__prompt_kernel:
    s_cmp_ge_u32 s2, 256
    s_cbranch_scc1 L_EXIT
    s_load_dwordx16 s[16:31], s[0:1], 0
    s_load_dwordx16 s[32:47], s[0:1], 64
    s_getpc_b64 s[4:5]
L_PC:
    v_lshrrev_b32 v2, 6, v0
    s_and_b32 s71, s2, 7
    s_lshr_b32 s72, s2, 3
    v_readfirstlane_b32 s69, v2
    v_and_b32 v1, 63, v0
    s_cmp_lg_u32 s69, 7
    s_cbranch_scc1 L_NOPF
    s_lshl_b32 s88, s72, 11
    v_and_b32 v2, 15, v0
    v_lshl_add_u32 v2, v2, 7, s88
    v_min_u32 v2, L_CODE_END-L_PC-4, v2
    global_load_dword v253, v2, s[4:5]
L_NOPF:
    s_mov_b32 s50, 1835008
    s_mov_b32 s51, 0x20000
    s_mov_b32 s62, 268435456
    s_mov_b32 s63, 0x20000
    s_mov_b32 s54, 1605632
    s_mov_b32 s55, 0x20000
    s_mov_b32 s58, 1605632
    s_mov_b32 s59, 0x20000
    s_mov_b32 s66, 1835008
    s_mov_b32 s67, 0x20000
    s_and_b32 s70, s69, 3
    s_cmp_ge_u32 s72, 28
    s_cbranch_scc1 L_HELPER
    s_mul_i32 s78, s71, 28
    s_add_u32 s78, s78, s72
    s_lshl_b32 s88, s78, 10
    v_lshl_add_u32 v34, v0, 1, s88
    s_lshl_b32 s88, s78, 2
    v_mov_b32 v33, s88
    v_lshrrev_b32 v35, 8, v0
    v_lshl_add_u32 v35, v35, 1, s88
    s_waitcnt lgkmcnt(0)
    global_load_ushort v46, v35, s[30:31]
    global_load_ushort v40, v34, s[18:19]
    global_load_ushort v41, v34, s[20:21]
    global_load_ushort v42, v34, s[22:23]
    global_load_ushort v43, v34, s[24:25]
    global_load_ushort v44, v34, s[26:27]
    global_load_ushort v45, v34, s[28:29]
    global_load_dword v31, v33, s[32:33]
    s_load_dword s68, s[46:47], 0
    s_mov_b64 s[48:49], s[16:17]
    s_mov_b64 s[60:61], s[46:47]
    s_mov_b64 s[56:57], s[40:41]
    s_mov_b64 s[64:65], s[42:43]
    s_mul_i32 s88, s72, 37
    s_lshr_b32 s88, s88, 8
    s_mul_i32 s89, s88, 7
    s_sub_u32 s76, s72, s89
    s_and_b32 s89, s71, 6
    s_lshl1_add_u32 s73, s89, s88
    s_and_b32 s89, s71, 1
    s_mul_i32 s89, s89, 7
    s_add_u32 s74, s89, s76
    s_lshl2_add_u32 s75, s71, s88
    s_lshl_b32 s8, s70, 12
    s_mul_i32 s79, s69, 4608
    s_lshl_b32 s90, s71, 2
    s_mov_b32 s88, 0x06543210
    s_mov_b32 s89, 0x00654321
    s_lshr_b64 s[88:89], s[88:89], s90
    s_bfe_u32 s80, s88, 0x40000
    s_bfe_u32 s81, s88, 0x40004
    s_bfe_u32 s82, s88, 0x40008
    s_bfe_u32 s83, s88, 0x4000c
    s_bfe_u32 s84, s88, 0x40010
    s_bfe_u32 s85, s88, 0x40014
    s_bfe_u32 s86, s88, 0x40018
    s_cmp_ge_u32 s70, 2
    s_cselect_b32 s52, s38, s36
    s_cselect_b32 s53, s39, s37
    s_lshr_b32 s89, s70, 1
    s_lshl1_add_u32 s88, s73, s89
    s_lshr_b32 s89, s88, 2
    s_lshl_b32 s89, s89, 8
    s_and_b32 s88, s88, 3
    s_lshl3_add_u32 s88, s88, s89
    s_and_b32 s89, s70, 1
    s_lshl_b32 s89, s89, 7
    s_add_u32 s77, s88, s89
    s_cmp_ge_u32 s69, 4
    s_cbranch_scc1 L_B
    v_lshrrev_b32 v249, 5, v1
    v_bfe_u32 v250, v1, 3, 2
    v_lshl_add_u32 v249, v250, 1, v249
    v_add_u32 v249, s77, v249
    v_mul_u32_u24 v2, 896, v249
    v_lshrrev_b32 v249, 4, v1
    v_and_b32 v250, 7, v1
    v_xor_b32 v250, v250, v249
    v_lshl_add_u32 v2, v250, 4, v2
    v_xor_b32 v3, 64, v2
    v_add_u32 v4, 55296, v2
    v_add_u32 v5, 82944, v3
    v_add_u32 v3, 27648, v3
    s_add_u32 m0, s8, 49152
    s_lshl_b32 s87, s80, 7
    buffer_load_dwordx4 v2, s[48:51], s87 offen offset:0 lds
    buffer_load_dwordx4 v3, s[48:51], s87 offen offset:1024 lds
    buffer_load_dwordx4 v4, s[48:51], s87 offen offset:2048 lds
    buffer_load_dwordx4 v5, s[48:51], s87 offen offset:3072 lds
    v_and_b32 v249, 15, v1
    v_lshrrev_b32 v250, 4, v1
    v_mul_u32_u24 v34, 288, v249
    v_lshl_add_u32 v34, v250, 4, v34
    v_add_u32 v34, s79, v34
    v_lshrrev_b32 v249, 3, v1
    v_and_b32 v250, 7, v1
    v_mul_u32_u24 v244, 896, v249
    v_bfe_u32 v249, v1, 4, 1
    v_lshlrev_b32 v249, 2, v249
    v_xor_b32 v250, v250, v249
    v_lshl_add_u32 v244, v250, 4, v244
    s_lshr_b32 s89, s70, 1
    s_mul_i32 s89, s89, 114688
    s_and_b32 s88, s70, 1
    s_mul_i32 s88, s88, 28672
    s_add_u32 s89, s89, s88
    s_lshl_b32 s88, s76, 7
    s_add_u32 s89, s89, s88
    v_add_u32 v244, s89, v244
    v_add_u32 v245, 6144, v244
    v_add_u32 v246, 12288, v244
    v_add_u32 v247, 18432, v244
    s_waitcnt lgkmcnt(0)
    s_mul_i32 s68, s68, 0x19660d
    s_add_u32 s68, s68, 0x3c6ef35f
    s_mov_b32 m0, s79
    s_waitcnt vmcnt(9)
    v_lshlrev_b32 v46, 16, v46
    v_lshlrev_b32 v40, 16, v40
    v_lshlrev_b32 v41, 16, v41
    s_mov_b32 s88, 0x3fb8aa3b
    v_mul_f32 v36, s88, v46
    v_fma_f32 v37, v46, s88, -v36
    v_exp_f32 v36, v36
    v_fmac_f32 v37, 0x32a57060, v46
    v_mul_f32 v37, 0x3f317218, v37
    v_fma_f32 v47, v36, v37, v36
    v_cvt_pk_bf16_f32 v47, v47, v47
    v_lshlrev_b32 v47, 16, v47
    v_mul_f32 v48, v47, v40
    v_mul_f32 v49, v47, v41
    v_mul_f32 v48, s88, v48
    v_mul_f32 v49, 0x3e22f983, v49
    v_mul_f32 v36, 0x41000000, v48
    v_mul_f32 v37, 0x41000000, v49
    s_mul_i32 s9, s83, 229376
    s_add_u32 s9, s9, 57344
    buffer_load_dwordx4 v[176:179], v244, s[56:59], s9 offen offset:0
    v_fract_f32 v37, v37
    v_exp_f32 v36, v36
    v_cos_f32 v52, v37
    v_sin_f32 v53, v37
    s_nop 0
    v_pk_mul_f32 v[52:53], v[52:53], v[36:37] op_sel_hi:[1,0]
    v_mov_b32 v71, 0x3f80
    ds_write_addtid_b32 v71 offset:0
    v_cvt_pk_bf16_f32 v68, v52, v53
    ds_write_addtid_b32 v68 offset:288
    v_pk_mul_f32 v[64:65], v[52:53], v[52:53] op_sel:[0,0] op_sel_hi:[0,1]
    v_pk_fma_f32 v[60:61], v[52:53], v[52:53], v[64:65] op_sel:[1,1,0] op_sel_hi:[1,0,1] neg_lo:[1,0,0]
    v_cvt_pk_bf16_f32 v69, v60, v61
    ds_write_addtid_b32 v69 offset:576
    buffer_load_dwordx4 v[180:183], v245, s[56:59], s9 offen offset:1024
    v_pk_mul_f32 v[64:65], v[60:61], v[52:53] op_sel:[0,0] op_sel_hi:[0,1]
    v_pk_fma_f32 v[60:61], v[60:61], v[52:53], v[64:65] op_sel:[1,1,0] op_sel_hi:[1,0,1] neg_lo:[1,0,0]
    v_cvt_pk_bf16_f32 v70, v60, v61
    ds_write_addtid_b32 v70 offset:864
    v_pk_mul_f32 v[64:65], v[60:61], v[52:53] op_sel:[0,0] op_sel_hi:[0,1]
    v_pk_fma_f32 v[60:61], v[60:61], v[52:53], v[64:65] op_sel:[1,1,0] op_sel_hi:[1,0,1] neg_lo:[1,0,0]
    v_cvt_pk_bf16_f32 v71, v60, v61
    ds_write_addtid_b32 v71 offset:1152
    v_pk_mul_f32 v[64:65], v[60:61], v[52:53] op_sel:[0,0] op_sel_hi:[0,1]
    v_pk_fma_f32 v[60:61], v[60:61], v[52:53], v[64:65] op_sel:[1,1,0] op_sel_hi:[1,0,1] neg_lo:[1,0,0]
    v_cvt_pk_bf16_f32 v68, v60, v61
    ds_write_addtid_b32 v68 offset:1440
    buffer_load_dwordx4 v[184:187], v246, s[56:59], s9 offen offset:2048
    v_pk_mul_f32 v[64:65], v[60:61], v[52:53] op_sel:[0,0] op_sel_hi:[0,1]
    v_pk_fma_f32 v[60:61], v[60:61], v[52:53], v[64:65] op_sel:[1,1,0] op_sel_hi:[1,0,1] neg_lo:[1,0,0]
    v_cvt_pk_bf16_f32 v69, v60, v61
    ds_write_addtid_b32 v69 offset:1728
    v_pk_mul_f32 v[64:65], v[60:61], v[52:53] op_sel:[0,0] op_sel_hi:[0,1]
    v_pk_fma_f32 v[60:61], v[60:61], v[52:53], v[64:65] op_sel:[1,1,0] op_sel_hi:[1,0,1] neg_lo:[1,0,0]
    v_cvt_pk_bf16_f32 v70, v60, v61
    ds_write_addtid_b32 v70 offset:2016
    v_pk_mul_f32 v[64:65], v[60:61], v[52:53] op_sel:[0,0] op_sel_hi:[0,1]
    v_pk_fma_f32 v[60:61], v[60:61], v[52:53], v[64:65] op_sel:[1,1,0] op_sel_hi:[1,0,1] neg_lo:[1,0,0]
    v_cvt_pk_bf16_f32 v71, v60, v61
    ds_write_addtid_b32 v71 offset:2304
    v_pk_mul_f32 v[64:65], v[60:61], v[52:53] op_sel:[0,0] op_sel_hi:[0,1]
    v_pk_fma_f32 v[60:61], v[60:61], v[52:53], v[64:65] op_sel:[1,1,0] op_sel_hi:[1,0,1] neg_lo:[1,0,0]
    v_cvt_pk_bf16_f32 v68, v60, v61
    buffer_load_dwordx4 v[188:191], v247, s[56:59], s9 offen offset:3072
    ds_write_addtid_b32 v68 offset:2592
    v_pk_mul_f32 v[64:65], v[60:61], v[52:53] op_sel:[0,0] op_sel_hi:[0,1]
    v_pk_fma_f32 v[60:61], v[60:61], v[52:53], v[64:65] op_sel:[1,1,0] op_sel_hi:[1,0,1] neg_lo:[1,0,0]
    v_cvt_pk_bf16_f32 v69, v60, v61
    ds_write_addtid_b32 v69 offset:2880
    v_pk_mul_f32 v[64:65], v[60:61], v[52:53] op_sel:[0,0] op_sel_hi:[0,1]
    v_pk_fma_f32 v[60:61], v[60:61], v[52:53], v[64:65] op_sel:[1,1,0] op_sel_hi:[1,0,1] neg_lo:[1,0,0]
    v_cvt_pk_bf16_f32 v70, v60, v61
    ds_write_addtid_b32 v70 offset:3168
    v_pk_mul_f32 v[64:65], v[60:61], v[52:53] op_sel:[0,0] op_sel_hi:[0,1]
    v_pk_fma_f32 v[60:61], v[60:61], v[52:53], v[64:65] op_sel:[1,1,0] op_sel_hi:[1,0,1] neg_lo:[1,0,0]
    v_cvt_pk_bf16_f32 v71, v60, v61
    ds_write_addtid_b32 v71 offset:3456
    s_mul_i32 s9, s84, 229376
    s_add_u32 s9, s9, 57344
    buffer_load_dwordx4 v[192:195], v244, s[56:59], s9 offen offset:0
    v_pk_mul_f32 v[64:65], v[60:61], v[52:53] op_sel:[0,0] op_sel_hi:[0,1]
    v_pk_fma_f32 v[60:61], v[60:61], v[52:53], v[64:65] op_sel:[1,1,0] op_sel_hi:[1,0,1] neg_lo:[1,0,0]
    v_cvt_pk_bf16_f32 v68, v60, v61
    ds_write_addtid_b32 v68 offset:3744
    v_pk_mul_f32 v[64:65], v[60:61], v[52:53] op_sel:[0,0] op_sel_hi:[0,1]
    v_pk_fma_f32 v[60:61], v[60:61], v[52:53], v[64:65] op_sel:[1,1,0] op_sel_hi:[1,0,1] neg_lo:[1,0,0]
    v_cvt_pk_bf16_f32 v69, v60, v61
    ds_write_addtid_b32 v69 offset:4032
    v_pk_mul_f32 v[64:65], v[60:61], v[52:53] op_sel:[0,0] op_sel_hi:[0,1]
    v_pk_fma_f32 v[60:61], v[60:61], v[52:53], v[64:65] op_sel:[1,1,0] op_sel_hi:[1,0,1] neg_lo:[1,0,0]
    v_cvt_pk_bf16_f32 v70, v60, v61
    ds_write_addtid_b32 v70 offset:4320
    ds_read_b128 v[72:75], v34 offset:0
    ds_read_b128 v[76:79], v34 offset:64
    buffer_load_dwordx4 v[196:199], v245, s[56:59], s9 offen offset:1024
    ds_read_b128 v[80:83], v34 offset:128
    ds_read_b128 v[84:87], v34 offset:192
    v_mul_f32 v36, 0x43000000, v48
    v_mul_f32 v37, 0x43000000, v49
    v_fract_f32 v37, v37
    v_exp_f32 v36, v36
    v_cos_f32 v60, v37
    v_sin_f32 v61, v37
    s_nop 0
    v_pk_mul_f32 v[60:61], v[60:61], v[36:37] op_sel_hi:[1,0]
    v_cvt_pk_bf16_f32 v71, v60, v61
    ds_write_addtid_b32 v71 offset:0
    v_pk_mul_f32 v[64:65], v[60:61], v[52:53] op_sel:[0,0] op_sel_hi:[0,1]
    v_pk_fma_f32 v[60:61], v[60:61], v[52:53], v[64:65] op_sel:[1,1,0] op_sel_hi:[1,0,1] neg_lo:[1,0,0]
    v_cvt_pk_bf16_f32 v68, v60, v61
    ds_write_addtid_b32 v68 offset:288
    buffer_load_dwordx4 v[200:203], v246, s[56:59], s9 offen offset:2048
    v_pk_mul_f32 v[64:65], v[60:61], v[52:53] op_sel:[0,0] op_sel_hi:[0,1]
    v_pk_fma_f32 v[60:61], v[60:61], v[52:53], v[64:65] op_sel:[1,1,0] op_sel_hi:[1,0,1] neg_lo:[1,0,0]
    v_cvt_pk_bf16_f32 v69, v60, v61
    ds_write_addtid_b32 v69 offset:576
    v_pk_mul_f32 v[64:65], v[60:61], v[52:53] op_sel:[0,0] op_sel_hi:[0,1]
    v_pk_fma_f32 v[60:61], v[60:61], v[52:53], v[64:65] op_sel:[1,1,0] op_sel_hi:[1,0,1] neg_lo:[1,0,0]
    v_cvt_pk_bf16_f32 v70, v60, v61
    ds_write_addtid_b32 v70 offset:864
    v_pk_mul_f32 v[64:65], v[60:61], v[52:53] op_sel:[0,0] op_sel_hi:[0,1]
    v_pk_fma_f32 v[60:61], v[60:61], v[52:53], v[64:65] op_sel:[1,1,0] op_sel_hi:[1,0,1] neg_lo:[1,0,0]
    v_cvt_pk_bf16_f32 v71, v60, v61
    ds_write_addtid_b32 v71 offset:1152
    v_pk_mul_f32 v[64:65], v[60:61], v[52:53] op_sel:[0,0] op_sel_hi:[0,1]
    buffer_load_dwordx4 v[204:207], v247, s[56:59], s9 offen offset:3072
    v_pk_fma_f32 v[60:61], v[60:61], v[52:53], v[64:65] op_sel:[1,1,0] op_sel_hi:[1,0,1] neg_lo:[1,0,0]
    v_cvt_pk_bf16_f32 v68, v60, v61
    ds_write_addtid_b32 v68 offset:1440
    v_pk_mul_f32 v[64:65], v[60:61], v[52:53] op_sel:[0,0] op_sel_hi:[0,1]
    v_pk_fma_f32 v[60:61], v[60:61], v[52:53], v[64:65] op_sel:[1,1,0] op_sel_hi:[1,0,1] neg_lo:[1,0,0]
    v_cvt_pk_bf16_f32 v69, v60, v61
    ds_write_addtid_b32 v69 offset:1728
    v_pk_mul_f32 v[64:65], v[60:61], v[52:53] op_sel:[0,0] op_sel_hi:[0,1]
    v_pk_fma_f32 v[60:61], v[60:61], v[52:53], v[64:65] op_sel:[1,1,0] op_sel_hi:[1,0,1] neg_lo:[1,0,0]
    v_cvt_pk_bf16_f32 v70, v60, v61
    ds_write_addtid_b32 v70 offset:2016
    v_pk_mul_f32 v[64:65], v[60:61], v[52:53] op_sel:[0,0] op_sel_hi:[0,1]
    v_pk_fma_f32 v[60:61], v[60:61], v[52:53], v[64:65] op_sel:[1,1,0] op_sel_hi:[1,0,1] neg_lo:[1,0,0]
    v_cvt_pk_bf16_f32 v71, v60, v61
    s_mul_i32 s9, s85, 229376
    s_add_u32 s9, s9, 57344
    buffer_load_dwordx4 v[208:211], v244, s[56:59], s9 offen offset:0
    ds_write_addtid_b32 v71 offset:2304
    v_pk_mul_f32 v[64:65], v[60:61], v[52:53] op_sel:[0,0] op_sel_hi:[0,1]
    v_pk_fma_f32 v[60:61], v[60:61], v[52:53], v[64:65] op_sel:[1,1,0] op_sel_hi:[1,0,1] neg_lo:[1,0,0]
    v_cvt_pk_bf16_f32 v68, v60, v61
    ds_write_addtid_b32 v68 offset:2592
    v_pk_mul_f32 v[64:65], v[60:61], v[52:53] op_sel:[0,0] op_sel_hi:[0,1]
    v_pk_fma_f32 v[60:61], v[60:61], v[52:53], v[64:65] op_sel:[1,1,0] op_sel_hi:[1,0,1] neg_lo:[1,0,0]
    v_cvt_pk_bf16_f32 v69, v60, v61
    ds_write_addtid_b32 v69 offset:2880
    v_pk_mul_f32 v[64:65], v[60:61], v[52:53] op_sel:[0,0] op_sel_hi:[0,1]
    v_pk_fma_f32 v[60:61], v[60:61], v[52:53], v[64:65] op_sel:[1,1,0] op_sel_hi:[1,0,1] neg_lo:[1,0,0]
    v_cvt_pk_bf16_f32 v70, v60, v61
    ds_write_addtid_b32 v70 offset:3168
    buffer_load_dwordx4 v[212:215], v245, s[56:59], s9 offen offset:1024
    v_pk_mul_f32 v[64:65], v[60:61], v[52:53] op_sel:[0,0] op_sel_hi:[0,1]
    v_pk_fma_f32 v[60:61], v[60:61], v[52:53], v[64:65] op_sel:[1,1,0] op_sel_hi:[1,0,1] neg_lo:[1,0,0]
    v_cvt_pk_bf16_f32 v71, v60, v61
    ds_write_addtid_b32 v71 offset:3456
    v_pk_mul_f32 v[64:65], v[60:61], v[52:53] op_sel:[0,0] op_sel_hi:[0,1]
    v_pk_fma_f32 v[60:61], v[60:61], v[52:53], v[64:65] op_sel:[1,1,0] op_sel_hi:[1,0,1] neg_lo:[1,0,0]
    v_cvt_pk_bf16_f32 v68, v60, v61
    ds_write_addtid_b32 v68 offset:3744
    v_pk_mul_f32 v[64:65], v[60:61], v[52:53] op_sel:[0,0] op_sel_hi:[0,1]
    v_pk_fma_f32 v[60:61], v[60:61], v[52:53], v[64:65] op_sel:[1,1,0] op_sel_hi:[1,0,1] neg_lo:[1,0,0]
    v_cvt_pk_bf16_f32 v69, v60, v61
    ds_write_addtid_b32 v69 offset:4032
    v_pk_mul_f32 v[64:65], v[60:61], v[52:53] op_sel:[0,0] op_sel_hi:[0,1]
    v_pk_fma_f32 v[60:61], v[60:61], v[52:53], v[64:65] op_sel:[1,1,0] op_sel_hi:[1,0,1] neg_lo:[1,0,0]
    v_cvt_pk_bf16_f32 v70, v60, v61
    buffer_load_dwordx4 v[216:219], v246, s[56:59], s9 offen offset:2048
    ds_write_addtid_b32 v70 offset:4320
    ds_read_b128 v[88:91], v34 offset:0
    ds_read_b128 v[92:95], v34 offset:64
    ds_read_b128 v[96:99], v34 offset:128
    ds_read_b128 v[100:103], v34 offset:192
    v_mul_f32 v36, 0x43800000, v48
    v_mul_f32 v37, 0x43800000, v49
    v_fract_f32 v37, v37
    v_exp_f32 v36, v36
    v_cos_f32 v54, v37
    v_sin_f32 v55, v37
    s_nop 0
    v_pk_mul_f32 v[54:55], v[54:55], v[36:37] op_sel_hi:[1,0]
    s_waitcnt vmcnt(15)
    v_lshlrev_b32 v42, 16, v42
    buffer_load_dwordx4 v[220:223], v247, s[56:59], s9 offen offset:3072
    v_lshlrev_b32 v43, 16, v43
    v_lshlrev_b32 v44, 16, v44
    v_lshlrev_b32 v45, 16, v45
    v_pk_mul_f32 v[64:65], v[44:45], v[42:43] op_sel:[0,0] op_sel_hi:[0,1]
    v_pk_fma_f32 v[58:59], v[44:45], v[42:43], v[64:65] op_sel:[1,1,0] op_sel_hi:[1,0,1] neg_lo:[1,0,0]
    v_mul_f32 v58, v47, v58
    v_mul_f32 v59, v47, v59
    v_pk_mul_f32 v[64:65], v[58:59], v[54:55] op_sel:[0,0] op_sel_hi:[0,1]
    v_pk_fma_f32 v[136:137], v[58:59], v[54:55], v[64:65] op_sel:[1,1,0] op_sel_hi:[1,0,1] neg_lo:[1,0,0]
    v_pk_mul_f32 v[64:65], v[136:137], v[54:55] op_sel:[0,0] op_sel_hi:[0,1]
    v_pk_fma_f32 v[138:139], v[136:137], v[54:55], v[64:65] op_sel:[1,1,0] op_sel_hi:[1,0,1] neg_lo:[1,0,0]
    v_pk_mul_f32 v[64:65], v[138:139], v[54:55] op_sel:[0,0] op_sel_hi:[0,1]
    v_pk_fma_f32 v[140:141], v[138:139], v[54:55], v[64:65] op_sel:[1,1,0] op_sel_hi:[1,0,1] neg_lo:[1,0,0]
    v_pk_mul_f32 v[64:65], v[140:141], v[54:55] op_sel:[0,0] op_sel_hi:[0,1]
    v_pk_fma_f32 v[60:61], v[140:141], v[54:55], v[64:65] op_sel:[1,1,0] op_sel_hi:[1,0,1] neg_lo:[1,0,0]
    v_cvt_pk_bf16_f32 v71, v60, -v61
    ds_write_addtid_b32 v71 offset:0
    v_pk_mul_f32 v[64:65], v[60:61], v[54:55] op_sel:[0,0] op_sel_hi:[0,1]
    v_pk_fma_f32 v[60:61], v[60:61], v[54:55], v[64:65] op_sel:[1,1,0] op_sel_hi:[1,0,1] neg_lo:[1,0,0]
    s_mul_i32 s9, s86, 229376
    s_add_u32 s9, s9, 57344
    buffer_load_dwordx4 v[224:227], v244, s[56:59], s9 offen offset:0
    v_cvt_pk_bf16_f32 v68, v60, -v61
    ds_write_addtid_b32 v68 offset:288
    v_pk_mul_f32 v[64:65], v[60:61], v[54:55] op_sel:[0,0] op_sel_hi:[0,1]
    v_pk_fma_f32 v[60:61], v[60:61], v[54:55], v[64:65] op_sel:[1,1,0] op_sel_hi:[1,0,1] neg_lo:[1,0,0]
    v_cvt_pk_bf16_f32 v69, v60, -v61
    ds_write_addtid_b32 v69 offset:576
    v_pk_mul_f32 v[64:65], v[60:61], v[54:55] op_sel:[0,0] op_sel_hi:[0,1]
    v_pk_fma_f32 v[60:61], v[60:61], v[54:55], v[64:65] op_sel:[1,1,0] op_sel_hi:[1,0,1] neg_lo:[1,0,0]
    v_cvt_pk_bf16_f32 v70, v60, -v61
    ds_write_addtid_b32 v70 offset:864
    v_pk_mul_f32 v[64:65], v[60:61], v[54:55] op_sel:[0,0] op_sel_hi:[0,1]
    v_pk_fma_f32 v[60:61], v[60:61], v[54:55], v[64:65] op_sel:[1,1,0] op_sel_hi:[1,0,1] neg_lo:[1,0,0]
    v_cvt_pk_bf16_f32 v71, v60, -v61
    ds_write_addtid_b32 v71 offset:1152
    buffer_load_dwordx4 v[228:231], v245, s[56:59], s9 offen offset:1024
    ds_read_b128 v[120:123], v34 offset:0
    ds_read_b128 v[124:127], v34 offset:64
    ds_read_b128 v[128:131], v34 offset:128
    ds_read_b128 v[132:135], v34 offset:192
    v_fract_f32 v37, v49
    v_exp_f32 v36, v48
    v_cos_f32 v50, v37
    v_sin_f32 v51, v37
    s_nop 0
    v_pk_mul_f32 v[50:51], v[50:51], v[36:37] op_sel_hi:[1,0]
    v_cvt_pk_bf16_f32 v68, v58, -v59
    ds_write_addtid_b32 v68 offset:0
    v_cvt_pk_bf16_f32 v69, v136, -v137
    ds_write_addtid_b32 v69 offset:2304
    buffer_load_dwordx4 v[232:235], v246, s[56:59], s9 offen offset:2048
    v_cvt_pk_bf16_f32 v70, v138, -v139
    ds_write_addtid_b32 v70 offset:3456
    v_cvt_pk_bf16_f32 v71, v140, -v141
    ds_write_addtid_b32 v71 offset:4032
    s_waitcnt lgkmcnt(4)
    v_pk_mul_f32 v[64:65], v[58:59], v[50:51] op_sel:[0,0] op_sel_hi:[0,1]
    v_pk_fma_f32 v[60:61], v[58:59], v[50:51], v[64:65] op_sel:[1,1,0] op_sel_hi:[1,0,1] neg_lo:[1,0,0]
    v_cvt_pk_bf16_f32 v68, v60, -v61
    ds_write_addtid_b32 v68 offset:288
    buffer_load_dwordx4 v[236:239], v247, s[56:59], s9 offen offset:3072
    v_mfma_f32_16x16x32_bf16 v[156:159], v[120:123], v[72:75], 0
    v_pk_mul_f32 v[64:65], v[60:61], v[50:51] op_sel:[0,0] op_sel_hi:[0,1]
    v_pk_fma_f32 v[60:61], v[60:61], v[50:51], v[64:65] op_sel:[1,1,0] op_sel_hi:[1,0,1] neg_lo:[1,0,0]
    v_cvt_pk_bf16_f32 v69, v60, -v61
    ds_write_addtid_b32 v69 offset:576
    v_mfma_f32_16x16x32_bf16 v[160:163], v[120:123], v[88:91], 0
    v_pk_mul_f32 v[64:65], v[60:61], v[54:55] op_sel:[0,0] op_sel_hi:[0,1]
    v_pk_fma_f32 v[136:137], v[60:61], v[54:55], v[64:65] op_sel:[1,1,0] op_sel_hi:[1,0,1] neg_lo:[1,0,0]
    v_cvt_pk_bf16_f32 v70, v136, -v137
    ds_write_addtid_b32 v70 offset:2592
    v_pk_mul_f32 v[64:65], v[60:61], v[50:51] op_sel:[0,0] op_sel_hi:[0,1]
    v_pk_fma_f32 v[60:61], v[60:61], v[50:51], v[64:65] op_sel:[1,1,0] op_sel_hi:[1,0,1] neg_lo:[1,0,0]
    v_cvt_pk_bf16_f32 v71, v60, -v61
    ds_write_addtid_b32 v71 offset:864
    v_mfma_f32_16x16x32_bf16 v[156:159], v[124:127], v[76:79], v[156:159]
    v_pk_mul_f32 v[64:65], v[60:61], v[50:51] op_sel:[0,0] op_sel_hi:[0,1]
    v_pk_fma_f32 v[60:61], v[60:61], v[50:51], v[64:65] op_sel:[1,1,0] op_sel_hi:[1,0,1] neg_lo:[1,0,0]
    v_cvt_pk_bf16_f32 v68, v60, -v61
    ds_write_addtid_b32 v68 offset:1152
    v_mfma_f32_16x16x32_bf16 v[160:163], v[124:127], v[92:95], v[160:163]
    v_pk_mul_f32 v[64:65], v[60:61], v[54:55] op_sel:[0,0] op_sel_hi:[0,1]
    v_pk_fma_f32 v[136:137], v[60:61], v[54:55], v[64:65] op_sel:[1,1,0] op_sel_hi:[1,0,1] neg_lo:[1,0,0]
    v_cvt_pk_bf16_f32 v69, v136, -v137
    ds_write_addtid_b32 v69 offset:2880
    v_pk_mul_f32 v[64:65], v[136:137], v[54:55] op_sel:[0,0] op_sel_hi:[0,1]
    v_pk_fma_f32 v[136:137], v[136:137], v[54:55], v[64:65] op_sel:[1,1,0] op_sel_hi:[1,0,1] neg_lo:[1,0,0]
    v_cvt_pk_bf16_f32 v70, v136, -v137
    ds_write_addtid_b32 v70 offset:3744
    v_mfma_f32_16x16x32_bf16 v[156:159], v[128:131], v[80:83], v[156:159]
    v_pk_mul_f32 v[64:65], v[136:137], v[54:55] op_sel:[0,0] op_sel_hi:[0,1]
    v_pk_fma_f32 v[136:137], v[136:137], v[54:55], v[64:65] op_sel:[1,1,0] op_sel_hi:[1,0,1] neg_lo:[1,0,0]
    v_cvt_pk_bf16_f32 v71, v136, -v137
    ds_write_addtid_b32 v71 offset:4320
    v_pk_mul_f32 v[64:65], v[60:61], v[50:51] op_sel:[0,0] op_sel_hi:[0,1]
    v_pk_fma_f32 v[60:61], v[60:61], v[50:51], v[64:65] op_sel:[1,1,0] op_sel_hi:[1,0,1] neg_lo:[1,0,0]
    v_cvt_pk_bf16_f32 v68, v60, -v61
    ds_write_addtid_b32 v68 offset:1440
    v_mfma_f32_16x16x32_bf16 v[160:163], v[128:131], v[96:99], v[160:163]
    v_pk_mul_f32 v[64:65], v[60:61], v[50:51] op_sel:[0,0] op_sel_hi:[0,1]
    v_pk_fma_f32 v[60:61], v[60:61], v[50:51], v[64:65] op_sel:[1,1,0] op_sel_hi:[1,0,1] neg_lo:[1,0,0]
    v_cvt_pk_bf16_f32 v69, v60, -v61
    ds_write_addtid_b32 v69 offset:1728
    v_mfma_f32_16x16x32_bf16 v[156:159], v[132:135], v[84:87], v[156:159]
    v_pk_mul_f32 v[64:65], v[60:61], v[54:55] op_sel:[0,0] op_sel_hi:[0,1]
    v_pk_fma_f32 v[136:137], v[60:61], v[54:55], v[64:65] op_sel:[1,1,0] op_sel_hi:[1,0,1] neg_lo:[1,0,0]
    v_cvt_pk_bf16_f32 v70, v136, -v137
    ds_write_addtid_b32 v70 offset:3168
    v_pk_mul_f32 v[64:65], v[60:61], v[50:51] op_sel:[0,0] op_sel_hi:[0,1]
    v_pk_fma_f32 v[60:61], v[60:61], v[50:51], v[64:65] op_sel:[1,1,0] op_sel_hi:[1,0,1] neg_lo:[1,0,0]
    v_cvt_pk_bf16_f32 v71, v60, -v61
    ds_write_addtid_b32 v71 offset:2016
    v_mfma_f32_16x16x32_bf16 v[160:163], v[132:135], v[100:103], v[160:163]
    ds_read_b128 v[104:107], v34 offset:0
    ds_read_b128 v[108:111], v34 offset:64
    ds_read_b128 v[112:115], v34 offset:128
    ds_read_b128 v[116:119], v34 offset:192
    v_lshl_add_u32 v36, v1, 4, s79
    ds_write_b128 v36, v[156:159] offset:2048
    s_add_u32 m0, s8, 81920
    s_lshl_b32 s87, s81, 7
    buffer_load_dwordx4 v2, s[48:51], s87 offen offset:0 lds
    s_mov_b32 m0, s79
    ds_write_b128 v36, v[160:163] offset:3072
    s_waitcnt lgkmcnt(2)
    s_add_u32 m0, s8, 81920
    s_nop 0
    buffer_load_dwordx4 v3, s[48:51], s87 offen offset:1024 lds
    s_mov_b32 m0, s79
    v_mfma_f32_16x16x32_bf16 v[148:151], v[104:107], v[72:75], 0
    v_mfma_f32_16x16x32_bf16 v[152:155], v[104:107], v[88:91], 0
    v_mfma_f32_16x16x32_bf16 v[148:151], v[108:111], v[76:79], v[148:151]
    s_add_u32 m0, s8, 81920
    s_nop 0
    buffer_load_dwordx4 v4, s[48:51], s87 offen offset:2048 lds
    s_mov_b32 m0, s79
    v_mfma_f32_16x16x32_bf16 v[152:155], v[108:111], v[92:95], v[152:155]
    v_mfma_f32_16x16x32_bf16 v[148:151], v[112:115], v[80:83], v[148:151]
    v_mfma_f32_16x16x32_bf16 v[152:155], v[112:115], v[96:99], v[152:155]
    v_mfma_f32_16x16x32_bf16 v[148:151], v[116:119], v[84:87], v[148:151]
    s_add_u32 m0, s8, 81920
    s_nop 0
    buffer_load_dwordx4 v5, s[48:51], s87 offen offset:3072 lds
    s_mov_b32 m0, s79
    v_mfma_f32_16x16x32_bf16 v[152:155], v[116:119], v[100:103], v[152:155]
    s_nop 2
    ds_write_b128 v36, v[148:151] offset:0
    s_nop 3
    ds_write_b128 v36, v[152:155] offset:1024
    v_lshrrev_b32 v249, 5, v1
    v_bfe_u32 v250, v1, 1, 3
    v_xor_b32 v249, v249, v250
    s_and_b32 s89, s8, 8192
    s_add_u32 s89, s89, 49152
    v_lshl_add_u32 v249, v249, 4, s89
    v_and_b32 v250, 31, v1
    v_lshl_add_u32 v18, v250, 7, v249
    v_xor_b32 v19, 32, v18
    v_xor_b32 v20, 64, v18
    v_xor_b32 v21, 96, v18
    v_add_u32 v22, 65536, v18
    v_add_u32 v23, 65536, v19
    v_add_u32 v24, 65536, v20
    v_add_u32 v25, 65536, v21
    v_bfe_u32 v249, v1, 4, 1
    v_mul_u32_u24 v10, 8256, v249
    v_lshrrev_b32 v249, 5, v1
    v_lshl_add_u32 v10, v249, 10, v10
    v_bfe_u32 v249, v1, 2, 2
    v_lshl_add_u32 v10, v249, 7, v10
    v_bfe_u32 v249, v1, 3, 1
    v_lshl_add_u32 v10, v249, 5, v10
    v_and_b32 v249, 1, v1
    v_lshl_add_u32 v10, v249, 4, v10
    v_bfe_u32 v249, v1, 1, 1
    v_lshl_add_u32 v10, v249, 3, v10
    v_add_u32 v10, 49152, v10
    s_and_b32 s89, s70, 1
    s_lshl_b32 s89, s89, 6
    v_xor_b32 v10, s89, v10
    v_xor_b32 v11, 32, v10
    v_add_u32 v14, 65536, v10
    v_add_u32 v15, 65536, v11
    s_waitcnt lgkmcnt(0)
    s_waitcnt vmcnt(20)
    s_barrier
    s_setprio 2
    ds_read_b128 v[136:139], v18 offset:0
    ds_read_b64_tr_b16 v[128:129], v10 offset:16384
    ds_read_b64_tr_b16 v[130:131], v10 offset:16896
    ds_read_b64_tr_b16 v[132:133], v11 offset:16384
    ds_read_b64_tr_b16 v[134:135], v11 offset:16896
    ds_read_b128 v[140:143], v18 offset:4096
    s_waitcnt lgkmcnt(3)
    v_mfma_f32_32x32x16_bf16 v[64:79], v[128:131], v[136:139], 0
    ds_read_b128 v[152:155], v19 offset:0
    ds_read_b64_tr_b16 v[144:145], v10 offset:18432
    ds_read_b64_tr_b16 v[146:147], v10 offset:18944
    v_lshrrev_b32 v36, 5, v0
    s_waitcnt lgkmcnt(4)
    v_mfma_f32_32x32x16_bf16 v[80:95], v[132:135], v[136:139], 0
    ds_read_b64_tr_b16 v[148:149], v11 offset:18432
    ds_read_b64_tr_b16 v[150:151], v11 offset:18944
    ds_read_b128 v[156:159], v19 offset:4096
    v_and_b32 v37, 31, v0
    s_waitcnt lgkmcnt(6)
    v_mfma_f32_32x32x16_bf16 v[96:111], v[128:131], v[140:143], 0
    ds_read_b128 v[168:171], v20 offset:0
    ds_read_b64_tr_b16 v[160:161], v10 offset:20480
    ds_read_b64_tr_b16 v[162:163], v10 offset:20992
    v_lshrrev_b32 v38, 2, v36
    v_mfma_f32_32x32x16_bf16 v[112:127], v[132:135], v[140:143], 0
    ds_read_b64_tr_b16 v[164:165], v11 offset:20480
    ds_read_b64_tr_b16 v[166:167], v11 offset:20992
    v_lshlrev_b32 v32, 11, v38
    v_lshrrev_b32 v38, 4, v37
    s_waitcnt lgkmcnt(6)
    v_mfma_f32_32x32x16_bf16 v[64:79], v[144:147], v[152:155], v[64:79]
    ds_read_b128 v[172:175], v20 offset:4096
    v_lshl_add_u32 v32, v38, 10, v32
    v_and_b32 v38, 3, v36
    v_lshl_add_u32 v32, v38, 8, v32
    v_mfma_f32_32x32x16_bf16 v[80:95], v[148:151], v[152:155], v[80:95]
    ds_read_b128 v[136:139], v21 offset:0
    ds_read_b64_tr_b16 v[128:129], v10 offset:22528
    v_and_b32 v38, 15, v37
    v_lshl_add_u32 v32, v38, 4, v32
    s_waitcnt lgkmcnt(8)
    v_mfma_f32_32x32x16_bf16 v[96:111], v[144:147], v[156:159], v[96:111]
    ds_read_b64_tr_b16 v[130:131], v10 offset:23040
    ds_read_b64_tr_b16 v[132:133], v11 offset:22528
    v_med3_i32 v38, v36, 1, 4
    v_sub_u32 v38, 6, v38
    v_mfma_f32_32x32x16_bf16 v[112:127], v[148:151], v[156:159], v[112:127]
    ds_read_b64_tr_b16 v[134:135], v11 offset:23040
    ds_read_b128 v[140:143], v21 offset:4096
    v_lshlrev_b32 v37, v38, v37
    v_cmp_eq_u32 vcc, 1, v36
    s_waitcnt lgkmcnt(7)
    v_mfma_f32_32x32x16_bf16 v[64:79], v[160:163], v[168:171], v[64:79]
    v_lshlrev_b32 v38, 9, v36
    v_mov_b32 v39, 128
    v_cndmask_b32_e64 v38, v38, 16, vcc
    v_cmp_le_u32 vcc, 4, v36
    v_mfma_f32_32x32x16_bf16 v[80:95], v[164:167], v[168:171], v[80:95]
    v_add_u32 v12, v37, v38
    v_mov_b32 v38, 256
    v_cndmask_b32 v37, 4, v39, vcc
    v_cmp_le_u32 vcc, 3, v36
    s_waitcnt lgkmcnt(6)
    v_mfma_f32_32x32x16_bf16 v[96:111], v[160:163], v[172:175], v[96:111]
    v_add_u32 v13, v12, v37
    s_nop 0
    v_cndmask_b32 v38, 8, v38, vcc
    v_add_u32 v16, v12, v38
    v_mfma_f32_32x32x16_bf16 v[112:127], v[164:167], v[172:175], v[112:127]
    v_add_u32 v17, v13, v38
    v_lshrrev_b32 v37, 7, v12
    v_lshl_add_u32 v12, v37, 2, v12
    v_lshrrev_b32 v37, 7, v13
    s_waitcnt vmcnt(0)
    s_waitcnt lgkmcnt(0)
    v_mfma_f32_32x32x16_bf16 v[64:79], v[128:131], v[136:139], v[64:79]
    s_barrier
    ds_read_b128 v[152:155], v18 offset:32768
    ds_read_b64_tr_b16 v[144:145], v10 offset:49152
    ds_read_b64_tr_b16 v[146:147], v10 offset:49664
    v_lshl_add_u32 v13, v37, 2, v13
    v_mfma_f32_32x32x16_bf16 v[80:95], v[132:135], v[136:139], v[80:95]
    ds_read_b64_tr_b16 v[148:149], v11 offset:49152
    ds_read_b64_tr_b16 v[150:151], v11 offset:49664
    ds_read_b128 v[156:159], v18 offset:36864
    v_lshrrev_b32 v37, 7, v16
    v_mfma_f32_32x32x16_bf16 v[96:111], v[128:131], v[140:143], v[96:111]
    ds_read_b128 v[168:171], v19 offset:32768
    ds_read_b64_tr_b16 v[160:161], v10 offset:51200
    ds_read_b64_tr_b16 v[162:163], v10 offset:51712
    v_lshl_add_u32 v16, v37, 2, v16
    v_mfma_f32_32x32x16_bf16 v[112:127], v[132:135], v[140:143], v[112:127]
    ds_read_b64_tr_b16 v[164:165], v11 offset:51200
    ds_read_b64_tr_b16 v[166:167], v11 offset:51712
    v_lshrrev_b32 v37, 7, v17
    v_lshl_add_u32 v17, v37, 2, v17
    s_waitcnt lgkmcnt(6)
    v_mfma_f32_32x32x16_bf16 v[64:79], v[144:147], v[152:155], v[64:79]
    ds_read_b128 v[172:175], v19 offset:36864
    v_cmp_eq_u32 vcc, 0, v0
    s_mul_i32 s88, s70, 4576
    s_add_u32 s88, s88, 4096
    v_mfma_f32_32x32x16_bf16 v[80:95], v[148:151], v[152:155], v[80:95]
    ds_read_b128 v[136:139], v20 offset:32768
    ds_read_b64_tr_b16 v[128:129], v10 offset:53248
    v_cndmask_b32 v31, 0, v31, vcc
    v_cmp_gt_u32 vcc, 56, v1
    s_waitcnt lgkmcnt(8)
    v_mfma_f32_32x32x16_bf16 v[96:111], v[144:147], v[156:159], v[96:111]
    ds_read_b64_tr_b16 v[130:131], v10 offset:53760
    ds_read_b64_tr_b16 v[132:133], v11 offset:53248
    s_mul_i32 s89, s70, 4224
    s_add_u32 s89, s89, 17856
    v_mfma_f32_32x32x16_bf16 v[112:127], v[148:151], v[156:159], v[112:127]
    ds_read_b64_tr_b16 v[134:135], v11 offset:53760
    ds_read_b128 v[140:143], v20 offset:36864
    v_mov_b32 v36, s88
    v_mov_b32 v37, s89
    s_waitcnt lgkmcnt(7)
    v_mfma_f32_32x32x16_bf16 v[64:79], v[160:163], v[168:171], v[64:79]
    v_cndmask_b32 v36, v37, v36, vcc
    v_lshl_add_u32 v33, v1, 3, v36
    v_and_b32 v48, 255, v0
    v_lshlrev_b32 v58, 5, v48
    v_mfma_f32_32x32x16_bf16 v[80:95], v[164:167], v[168:171], v[80:95]
    ds_read_b128 v[152:155], v21 offset:32768
    ds_read_b64_tr_b16 v[144:145], v10 offset:55296
    s_movk_i32 s88, 512
    v_mov_b32 v59, -69120
    s_waitcnt lgkmcnt(8)
    v_mfma_f32_32x32x16_bf16 v[96:111], v[160:163], v[172:175], v[96:111]
    ds_read_b64_tr_b16 v[146:147], v10 offset:55808
    ds_read_b64_tr_b16 v[148:149], v11 offset:55296
    v_add_u32 v49, 28, v58
    v_cvt_f32_i32 v38, v49
    v_mfma_f32_32x32x16_bf16 v[112:127], v[164:167], v[172:175], v[112:127]
    ds_read_b64_tr_b16 v[150:151], v11 offset:55808
    ds_read_b128 v[156:159], v21 offset:36864
    v_add_u32 v50, 24, v58
    v_cvt_f32_i32 v39, v50
    s_waitcnt lgkmcnt(7)
    v_mfma_f32_32x32x16_bf16 v[64:79], v[128:131], v[136:139], v[64:79]
    v_cvt_pk_bf16_f32 v38, v38, v39
    v_bfe_u32 v60, v38, 0, 16
    v_lshl_add_u32 v60, v60, 2, v59
    v_med3_i32 v49, v60, v49, s88
    v_mfma_f32_32x32x16_bf16 v[80:95], v[132:135], v[136:139], v[80:95]
    v_ashrrev_i32 v60, 7, v49
    v_lshl_add_u32 v49, v60, 2, v49
    v_bfe_u32 v60, v38, 16, 16
    v_lshl_add_u32 v60, v60, 2, v59
    s_waitcnt lgkmcnt(6)
    v_mfma_f32_32x32x16_bf16 v[96:111], v[128:131], v[140:143], v[96:111]
    v_med3_i32 v50, v60, v50, s88
    v_ashrrev_i32 v60, 7, v50
    v_lshl_add_u32 v50, v60, 2, v50
    v_add_u32 v51, 20, v58
    v_mfma_f32_32x32x16_bf16 v[112:127], v[132:135], v[140:143], v[112:127]
    v_cvt_f32_i32 v38, v51
    v_add_u32 v52, 16, v58
    v_cvt_f32_i32 v39, v52
    v_cvt_pk_bf16_f32 v38, v38, v39
    s_waitcnt lgkmcnt(0)
    v_mfma_f32_32x32x16_bf16 v[64:79], v[144:147], v[152:155], v[64:79]
    s_barrier
    ds_read_b128 v[168:171], v22 offset:0
    ds_read_b64_tr_b16 v[160:161], v14 offset:16384
    ds_read_b64_tr_b16 v[162:163], v14 offset:16896
    v_bfe_u32 v60, v38, 0, 16
    v_mfma_f32_32x32x16_bf16 v[80:95], v[148:151], v[152:155], v[80:95]
    ds_read_b64_tr_b16 v[164:165], v15 offset:16384
    ds_read_b64_tr_b16 v[166:167], v15 offset:16896
    ds_read_b128 v[172:175], v22 offset:4096
    v_lshl_add_u32 v60, v60, 2, v59
    v_mfma_f32_32x32x16_bf16 v[96:111], v[144:147], v[156:159], v[96:111]
    ds_read_b128 v[136:139], v23 offset:0
    ds_read_b64_tr_b16 v[128:129], v14 offset:18432
    ds_read_b64_tr_b16 v[130:131], v14 offset:18944
    v_med3_i32 v51, v60, v51, s88
    v_mfma_f32_32x32x16_bf16 v[112:127], v[148:151], v[156:159], v[112:127]
    ds_read_b64_tr_b16 v[132:133], v15 offset:18432
    ds_read_b64_tr_b16 v[134:135], v15 offset:18944
    v_ashrrev_i32 v60, 7, v51
    v_lshl_add_u32 v51, v60, 2, v51
    s_waitcnt lgkmcnt(6)
    v_mfma_f32_32x32x16_bf16 v[64:79], v[160:163], v[168:171], v[64:79]
    ds_read_b128 v[140:143], v23 offset:4096
    v_bfe_u32 v60, v38, 16, 16
    v_lshl_add_u32 v60, v60, 2, v59
    v_med3_i32 v52, v60, v52, s88
    v_mfma_f32_32x32x16_bf16 v[80:95], v[164:167], v[168:171], v[80:95]
    ds_read_b128 v[152:155], v24 offset:0
    ds_read_b64_tr_b16 v[144:145], v14 offset:20480
    v_ashrrev_i32 v60, 7, v52
    v_lshl_add_u32 v52, v60, 2, v52
    s_waitcnt lgkmcnt(8)
    v_mfma_f32_32x32x16_bf16 v[96:111], v[160:163], v[172:175], v[96:111]
    ds_read_b64_tr_b16 v[146:147], v14 offset:20992
    ds_read_b64_tr_b16 v[148:149], v15 offset:20480
    v_add_u32 v53, 12, v58
    v_cvt_f32_i32 v38, v53
    v_mfma_f32_32x32x16_bf16 v[112:127], v[164:167], v[172:175], v[112:127]
    ds_read_b64_tr_b16 v[150:151], v15 offset:20992
    ds_read_b128 v[156:159], v24 offset:4096
    v_add_u32 v54, 8, v58
    v_cvt_f32_i32 v39, v54
    s_waitcnt lgkmcnt(7)
    v_mfma_f32_32x32x16_bf16 v[64:79], v[128:131], v[136:139], v[64:79]
    v_cvt_pk_bf16_f32 v38, v38, v39
    v_bfe_u32 v60, v38, 0, 16
    v_lshl_add_u32 v60, v60, 2, v59
    v_med3_i32 v53, v60, v53, s88
    v_mfma_f32_32x32x16_bf16 v[80:95], v[132:135], v[136:139], v[80:95]
    ds_read_b128 v[168:171], v25 offset:0
    ds_read_b64_tr_b16 v[160:161], v14 offset:22528
    v_ashrrev_i32 v60, 7, v53
    v_lshl_add_u32 v53, v60, 2, v53
    s_waitcnt lgkmcnt(8)
    v_mfma_f32_32x32x16_bf16 v[96:111], v[128:131], v[140:143], v[96:111]
    ds_read_b64_tr_b16 v[162:163], v14 offset:23040
    ds_read_b64_tr_b16 v[164:165], v15 offset:22528
    v_bfe_u32 v60, v38, 16, 16
    v_lshl_add_u32 v60, v60, 2, v59
    v_mfma_f32_32x32x16_bf16 v[112:127], v[132:135], v[140:143], v[112:127]
    ds_read_b64_tr_b16 v[166:167], v15 offset:23040
    ds_read_b128 v[172:175], v25 offset:4096
    v_med3_i32 v54, v60, v54, s88
    v_ashrrev_i32 v60, 7, v54
    s_waitcnt lgkmcnt(7)
    v_mfma_f32_32x32x16_bf16 v[64:79], v[144:147], v[152:155], v[64:79]
    v_lshl_add_u32 v54, v60, 2, v54
    v_add_u32 v55, 4, v58
    v_cvt_f32_i32 v38, v55
    v_add_u32 v56, 0, v58
    v_mfma_f32_32x32x16_bf16 v[80:95], v[148:151], v[152:155], v[80:95]
    v_cvt_f32_i32 v39, v56
    v_cvt_pk_bf16_f32 v38, v38, v39
    v_bfe_u32 v60, v38, 0, 16
    v_lshl_add_u32 v60, v60, 2, v59
    s_waitcnt lgkmcnt(6)
    v_mfma_f32_32x32x16_bf16 v[96:111], v[144:147], v[156:159], v[96:111]
    v_med3_i32 v55, v60, v55, s88
    v_ashrrev_i32 v60, 7, v55
    v_lshl_add_u32 v55, v60, 2, v55
    v_bfe_u32 v60, v38, 16, 16
    v_mfma_f32_32x32x16_bf16 v[112:127], v[148:151], v[156:159], v[112:127]
    v_lshl_add_u32 v60, v60, 2, v59
    v_med3_i32 v56, v60, v56, s88
    v_ashrrev_i32 v60, 7, v56
    v_lshl_add_u32 v56, v60, 2, v56
    s_waitcnt lgkmcnt(0)
    v_mfma_f32_32x32x16_bf16 v[64:79], v[160:163], v[168:171], v[64:79]
    s_barrier
    ds_read_b128 v[136:139], v22 offset:32768
    ds_read_b64_tr_b16 v[128:129], v10 offset:0
    ds_read_b64_tr_b16 v[130:131], v10 offset:512
    v_add_u32 v57, -4, v58
    v_mfma_f32_32x32x16_bf16 v[80:95], v[164:167], v[168:171], v[80:95]
    ds_read_b64_tr_b16 v[132:133], v11 offset:0
    ds_read_b64_tr_b16 v[134:135], v11 offset:512
    ds_read_b128 v[140:143], v22 offset:36864
    v_cvt_f32_i32 v38, v57
    v_mfma_f32_32x32x16_bf16 v[96:111], v[160:163], v[172:175], v[96:111]
    ds_read_b128 v[152:155], v23 offset:32768
    ds_read_b64_tr_b16 v[144:145], v10 offset:2048
    ds_read_b64_tr_b16 v[146:147], v10 offset:2560
    v_max_f32 v38, 0, v38
    v_mfma_f32_32x32x16_bf16 v[112:127], v[164:167], v[172:175], v[112:127]
    ds_read_b64_tr_b16 v[148:149], v11 offset:2048
    ds_read_b64_tr_b16 v[150:151], v11 offset:2560
    v_cvt_pk_bf16_f32 v38, v38, v39
    v_bfe_u32 v60, v38, 0, 16
    s_waitcnt lgkmcnt(6)
    v_mfma_f32_32x32x16_bf16 v[64:79], v[128:131], v[136:139], v[64:79]
    ds_read_b128 v[156:159], v23 offset:36864
    v_lshl_add_u32 v60, v60, 2, v59
    v_med3_i32 v57, v60, v57, s88
    v_ashrrev_i32 v60, 7, v57
    v_mfma_f32_32x32x16_bf16 v[80:95], v[132:135], v[136:139], v[80:95]
    ds_read_b128 v[168:171], v24 offset:32768
    ds_read_b64_tr_b16 v[160:161], v10 offset:4096
    v_lshl_add_u32 v57, v60, 2, v57
    v_add_u32 v57, 16, v57
    s_waitcnt lgkmcnt(8)
    v_mfma_f32_32x32x16_bf16 v[96:111], v[128:131], v[140:143], v[96:111]
    ds_read_b64_tr_b16 v[162:163], v10 offset:4608
    ds_read_b64_tr_b16 v[164:165], v11 offset:4096
    v_sub_u32 v48, 255, v48
    v_lshlrev_b32 v48, 4, v48
    v_mfma_f32_32x32x16_bf16 v[112:127], v[132:135], v[140:143], v[112:127]
    ds_read_b64_tr_b16 v[166:167], v11 offset:4608
    ds_read_b128 v[172:175], v24 offset:36864
    v_bfe_u32 v249, v1, 3, 2
    v_bfe_u32 v250, v1, 2, 1
    s_waitcnt lgkmcnt(7)
    v_mfma_f32_32x32x16_bf16 v[64:79], v[144:147], v[152:155], v[64:79]
    v_lshl_add_u32 v249, v249, 5, v250
    v_and_b32 v250, 3, v1
    v_lshl_add_u32 v249, v250, 1, v249
    s_and_b32 s88, s77, 65407
    v_mfma_f32_32x32x16_bf16 v[80:95], v[148:151], v[152:155], v[80:95]
    ds_read_b128 v[136:139], v25 offset:32768
    ds_read_b64_tr_b16 v[128:129], v10 offset:6144
    s_lshl_b32 s88, s88, 3
    s_add_u32 s88, s88, 32768
    s_waitcnt lgkmcnt(8)
    v_mfma_f32_32x32x16_bf16 v[96:111], v[144:147], v[156:159], v[96:111]
    ds_read_b64_tr_b16 v[130:131], v10 offset:6656
    ds_read_b64_tr_b16 v[132:133], v11 offset:6144
    v_lshl_add_u32 v62, v249, 3, s88
    v_bfe_u32 v249, v1, 4, 1
    v_mfma_f32_32x32x16_bf16 v[112:127], v[148:151], v[156:159], v[112:127]
    ds_read_b64_tr_b16 v[134:135], v11 offset:6656
    ds_read_b128 v[140:143], v25 offset:36864
    v_mul_u32_u24 v249, 1792, v249
    v_add_u32 v249, v249, v250
    s_waitcnt lgkmcnt(7)
    v_mfma_f32_32x32x16_bf16 v[64:79], v[160:163], v[168:171], v[64:79]
    v_bfe_u32 v250, v1, 2, 1
    v_lshl_add_u32 v249, v250, 3, v249
    v_bfe_u32 v250, v1, 3, 1
    v_lshl_add_u32 v249, v250, 2, v249
    v_mfma_f32_32x32x16_bf16 v[80:95], v[164:167], v[168:171], v[80:95]
    v_lshrrev_b32 v250, 5, v1
    v_lshl_add_u32 v249, v250, 4, v249
    s_lshl_b32 s88, s74, 10
    s_add_u32 s88, s88, 49152
    s_waitcnt lgkmcnt(6)
    v_mfma_f32_32x32x16_bf16 v[96:111], v[160:163], v[172:175], v[96:111]
    s_and_b32 s89, s70, 1
    s_lshl_b32 s89, s89, 8
    s_add_u32 s88, s88, s89
    v_lshl_add_u32 v63, v249, 3, s88
    v_mfma_f32_32x32x16_bf16 v[112:127], v[164:167], v[172:175], v[112:127]
    v_lshlrev_b32 v248, 4, v1
    s_lshl_b32 s88, s73, 2
    s_and_b32 s89, s70, 2
    s_add_u32 s88, s88, s89
    s_waitcnt lgkmcnt(0)
    v_mfma_f32_32x32x16_bf16 v[64:79], v[128:131], v[136:139], v[64:79]
    s_barrier
    ds_read_b128 v[152:155], v18 offset:16384
    ds_read_b64_tr_b16 v[144:145], v10 offset:32768
    ds_read_b64_tr_b16 v[146:147], v10 offset:33280
    s_mul_i32 s95, s88, 114688
    v_mfma_f32_32x32x16_bf16 v[80:95], v[132:135], v[136:139], v[80:95]
    ds_read_b64_tr_b16 v[148:149], v11 offset:32768
    ds_read_b64_tr_b16 v[150:151], v11 offset:33280
    ds_read_b128 v[156:159], v18 offset:20480
    s_lshl_b32 s89, s74, 13
    v_mfma_f32_32x32x16_bf16 v[96:111], v[128:131], v[140:143], v[96:111]
    ds_read_b128 v[168:171], v19 offset:16384
    ds_read_b64_tr_b16 v[160:161], v10 offset:34816
    ds_read_b64_tr_b16 v[162:163], v10 offset:35328
    s_add_u32 s95, s95, s89
    v_mfma_f32_32x32x16_bf16 v[112:127], v[132:135], v[140:143], v[112:127]
    ds_read_b64_tr_b16 v[164:165], v11 offset:34816
    ds_read_b64_tr_b16 v[166:167], v11 offset:35328
    s_and_b32 s90, s70, 1
    s_lshl_b32 s89, s90, 11
    s_waitcnt lgkmcnt(6)
    v_mfma_f32_32x32x16_bf16 v[64:79], v[144:147], v[152:155], v[64:79]
    ds_read_b128 v[172:175], v19 offset:20480
    s_add_u32 s95, s95, s89
    s_add_u32 s95, s95, 4194304
    s_add_u32 s10, s95, 114688
    v_mfma_f32_32x32x16_bf16 v[80:95], v[148:151], v[152:155], v[80:95]
    ds_read_b128 v[136:139], v20 offset:16384
    ds_read_b64_tr_b16 v[128:129], v10 offset:36864
    s_lshl_b32 s96, s88, 8
    s_lshl_b32 s89, s74, 3
    s_waitcnt lgkmcnt(8)
    v_mfma_f32_32x32x16_bf16 v[96:111], v[144:147], v[156:159], v[96:111]
    ds_read_b64_tr_b16 v[130:131], v10 offset:37376
    ds_read_b64_tr_b16 v[132:133], v11 offset:36864
    s_add_u32 s96, s96, s89
    s_lshl_b32 s89, s90, 2
    v_mfma_f32_32x32x16_bf16 v[112:127], v[148:151], v[156:159], v[112:127]
    ds_read_b64_tr_b16 v[134:135], v11 offset:37376
    ds_read_b128 v[140:143], v20 offset:20480
    s_add_u32 s96, s96, s89
    s_lshl_b32 s96, s96, 3
    s_waitcnt lgkmcnt(7)
    v_mfma_f32_32x32x16_bf16 v[64:79], v[160:163], v[168:171], v[64:79]
    s_add_u32 s96, s96, 3932160
    v_and_b32 v249, 1, v1
    v_mul_u32_u24 v26, 4576, v249
    v_xor_b32 v249, 1, v249
    v_mfma_f32_32x32x16_bf16 v[80:95], v[164:167], v[168:171], v[80:95]
    ds_read_b128 v[152:155], v21 offset:16384
    ds_read_b64_tr_b16 v[144:145], v10 offset:38912
    v_mul_u32_u24 v27, 4224, v249
    v_lshrrev_b32 v249, 4, v1
    s_waitcnt lgkmcnt(8)
    v_mfma_f32_32x32x16_bf16 v[96:111], v[160:163], v[172:175], v[96:111]
    ds_read_b64_tr_b16 v[146:147], v10 offset:39424
    ds_read_b64_tr_b16 v[148:149], v11 offset:38912
    v_lshl_add_u32 v26, v249, 4, v26
    v_lshl_add_u32 v27, v249, 4, v27
    v_mfma_f32_32x32x16_bf16 v[112:127], v[164:167], v[172:175], v[112:127]
    ds_read_b64_tr_b16 v[150:151], v11 offset:39424
    ds_read_b128 v[156:159], v21 offset:20480
    v_bfe_u32 v250, v1, 1, 3
    v_lshl_add_u32 v27, v250, 3, v27
    s_waitcnt lgkmcnt(7)
    v_mfma_f32_32x32x16_bf16 v[64:79], v[128:131], v[136:139], v[64:79]
    v_lshlrev_b32 v250, 6, v250
    v_sub_u32 v26, v26, v250
    s_lshr_b32 s88, s70, 1
    s_and_b32 s90, s70, 1
    v_mfma_f32_32x32x16_bf16 v[80:95], v[132:135], v[136:139], v[80:95]
    s_lshl_b32 s90, s90, 8
    s_mul_i32 s89, s88, 9152
    s_add_u32 s89, s89, 448
    s_add_u32 s89, s89, s90
    s_waitcnt lgkmcnt(6)
    v_mfma_f32_32x32x16_bf16 v[96:111], v[128:131], v[140:143], v[96:111]
    v_add_u32 v26, s89, v26
    s_mul_i32 s89, s88, 8448
    s_add_u32 s89, s89, 18312
    s_add_u32 s89, s89, s90
    v_mfma_f32_32x32x16_bf16 v[112:127], v[132:135], v[140:143], v[112:127]
    v_add_u32 v27, s89, v27
    s_lshr_b32 s88, s78, 5
    s_lshl_b32 s88, s88, 10
    s_add_u32 s88, s88, 4096000
    s_waitcnt lgkmcnt(0)
    v_mfma_f32_32x32x16_bf16 v[64:79], v[144:147], v[152:155], v[64:79]
    s_barrier
    ds_read_b128 v[168:171], v18 offset:49152
    ds_read_b64_tr_b16 v[160:161], v14 offset:0
    ds_read_b64_tr_b16 v[162:163], v14 offset:512
    v_min_u32 v252, 31, v1
    v_mfma_f32_32x32x16_bf16 v[80:95], v[148:151], v[152:155], v[80:95]
    ds_read_b64_tr_b16 v[164:165], v15 offset:0
    ds_read_b64_tr_b16 v[166:167], v15 offset:512
    ds_read_b128 v[172:175], v18 offset:53248
    v_lshl_add_u32 v252, v252, 5, s88
    v_mfma_f32_32x32x16_bf16 v[96:111], v[144:147], v[156:159], v[96:111]
    ds_read_b128 v[136:139], v19 offset:49152
    ds_read_b64_tr_b16 v[128:129], v14 offset:2048
    ds_read_b64_tr_b16 v[130:131], v14 offset:2560
    s_lshr_b32 s88, s70, 1
    v_mfma_f32_32x32x16_bf16 v[112:127], v[148:151], v[156:159], v[112:127]
    ds_read_b64_tr_b16 v[132:133], v15 offset:2048
    ds_read_b64_tr_b16 v[134:135], v15 offset:2560
    s_lshl_b32 s89, s78, 1
    s_add_u32 s88, s88, s89
    s_waitcnt lgkmcnt(6)
    v_mfma_f32_32x32x16_bf16 v[64:79], v[160:163], v[168:171], v[64:79]
    ds_read_b128 v[140:143], v19 offset:53248
    s_and_b32 s90, s70, 1
    s_mul_i32 s11, s88, 4224
    s_add_u32 s11, s11, 131200
    v_mfma_f32_32x32x16_bf16 v[80:95], v[164:167], v[168:171], v[80:95]
    ds_read_b128 v[152:155], v20 offset:49152
    ds_read_b64_tr_b16 v[144:145], v14 offset:4096
    s_lshl_b32 s89, s90, 2
    s_sub_u32 s11, s11, s89
    s_waitcnt lgkmcnt(8)
    v_mfma_f32_32x32x16_bf16 v[96:111], v[160:163], v[172:175], v[96:111]
    ds_read_b64_tr_b16 v[146:147], v14 offset:4608
    ds_read_b64_tr_b16 v[148:149], v15 offset:4096
    s_lshl_b32 s6, s88, 12
    s_add_u32 s6, s6, 2097152
    v_mfma_f32_32x32x16_bf16 v[112:127], v[164:167], v[172:175], v[112:127]
    ds_read_b64_tr_b16 v[150:151], v15 offset:4608
    ds_read_b128 v[156:159], v20 offset:53248
    s_lshr_b32 s7, s88, 5
    s_lshl_b32 s7, s7, 8
    s_waitcnt lgkmcnt(7)
    v_mfma_f32_32x32x16_bf16 v[64:79], v[128:131], v[136:139], v[64:79]
    s_and_b32 s88, s88, 31
    s_lshl_b32 s88, s88, 2
    s_add_u32 s7, s7, s88
    s_lshl_b32 s89, s90, 7
    v_mfma_f32_32x32x16_bf16 v[80:95], v[132:135], v[136:139], v[80:95]
    ds_read_b128 v[168:171], v21 offset:49152
    ds_read_b64_tr_b16 v[160:161], v14 offset:6144
    s_add_u32 s7, s7, s89
    s_lshl_b32 s7, s7, 3
    s_waitcnt lgkmcnt(8)
    v_mfma_f32_32x32x16_bf16 v[96:111], v[128:131], v[140:143], v[96:111]
    ds_read_b64_tr_b16 v[162:163], v14 offset:6656
    ds_read_b64_tr_b16 v[164:165], v15 offset:6144
    s_add_u32 s7, s7, 4063232
    s_lshl_b32 s89, s90, 11
    v_mfma_f32_32x32x16_bf16 v[112:127], v[132:135], v[140:143], v[112:127]
    ds_read_b64_tr_b16 v[166:167], v15 offset:6656
    ds_read_b128 v[172:175], v21 offset:53248
    s_add_u32 s6, s6, s89
    s_lshr_b32 s88, s75, 4
    s_waitcnt lgkmcnt(7)
    v_mfma_f32_32x32x16_bf16 v[64:79], v[144:147], v[152:155], v[64:79]
    s_lshl_b32 s88, s88, 7
    s_lshl_b32 s89, s76, 2
    s_add_u32 s89, s89, s70
    s_lshr_b32 s90, s89, 1
    v_mfma_f32_32x32x16_bf16 v[80:95], v[148:151], v[152:155], v[80:95]
    s_lshl_b32 s90, s90, 8
    s_add_u32 s88, s88, s90
    s_and_b32 s90, s70, 1
    s_lshl_b32 s90, s90, 6
    s_waitcnt lgkmcnt(6)
    v_mfma_f32_32x32x16_bf16 v[96:111], v[144:147], v[156:159], v[96:111]
    s_add_u32 s88, s88, s90
    s_lshl_b32 s88, s88, 3
    s_add_u32 s88, s88, 4063232
    v_min_u32 v249, 15, v1
    v_mfma_f32_32x32x16_bf16 v[112:127], v[148:151], v[156:159], v[112:127]
    v_lshl_add_u32 v37, v249, 5, s88
    s_lshl_b32 s89, s89, 16
    s_lshl_b32 s90, s75, 7
    s_add_u32 s89, s89, s90
    s_waitcnt lgkmcnt(0)
    v_mfma_f32_32x32x16_bf16 v[64:79], v[160:163], v[168:171], v[64:79]
    s_barrier
    ds_read_b128 v[136:139], v22 offset:16384
    ds_read_b64_tr_b16 v[128:129], v14 offset:32768
    ds_read_b64_tr_b16 v[130:131], v14 offset:33280
    s_add_u32 s89, s89, 2097152
    v_mfma_f32_32x32x16_bf16 v[80:95], v[164:167], v[168:171], v[80:95]
    ds_read_b64_tr_b16 v[132:133], v15 offset:32768
    ds_read_b64_tr_b16 v[134:135], v15 offset:33280
    ds_read_b128 v[140:143], v22 offset:20480
    v_lshrrev_b32 v249, 3, v1
    v_mfma_f32_32x32x16_bf16 v[96:111], v[160:163], v[172:175], v[96:111]
    ds_read_b128 v[152:155], v23 offset:16384
    ds_read_b64_tr_b16 v[144:145], v14 offset:34816
    ds_read_b64_tr_b16 v[146:147], v14 offset:35328
    v_lshl_add_u32 v36, v249, 12, s89
    v_mfma_f32_32x32x16_bf16 v[112:127], v[164:167], v[172:175], v[112:127]
    ds_read_b64_tr_b16 v[148:149], v15 offset:34816
    ds_read_b64_tr_b16 v[150:151], v15 offset:35328
    v_and_b32 v249, 7, v1
    v_lshl_add_u32 v36, v249, 4, v36
    s_waitcnt lgkmcnt(6)
    v_mfma_f32_32x32x16_bf16 v[64:79], v[128:131], v[136:139], v[64:79]
    ds_read_b128 v[156:159], v23 offset:20480
    v_bfe_u32 v249, v1, 2, 2
    s_lshl_b32 s88, s70, 11
    s_add_u32 s88, s88, 131072
    v_mfma_f32_32x32x16_bf16 v[80:95], v[132:135], v[136:139], v[80:95]
    ds_read_b128 v[168:171], v24 offset:16384
    ds_read_b64_tr_b16 v[160:161], v14 offset:36864
    v_lshl_add_u32 v38, v249, 7, s88
    v_lshrrev_b32 v249, 4, v1
    s_waitcnt lgkmcnt(8)
    v_mfma_f32_32x32x16_bf16 v[96:111], v[128:131], v[140:143], v[96:111]
    ds_read_b64_tr_b16 v[162:163], v14 offset:37376
    ds_read_b64_tr_b16 v[164:165], v15 offset:36864
    v_lshl_add_u32 v38, v249, 5, v38
    v_and_b32 v249, 3, v1
    v_mfma_f32_32x32x16_bf16 v[112:127], v[132:135], v[140:143], v[112:127]
    ds_read_b64_tr_b16 v[166:167], v15 offset:37376
    ds_read_b128 v[172:175], v24 offset:20480
    v_lshl_add_u32 v38, v249, 3, v38
    s_lshl_b32 s88, s70, 5
    s_waitcnt lgkmcnt(7)
    v_mfma_f32_32x32x16_bf16 v[64:79], v[144:147], v[152:155], v[64:79]
    s_add_u32 s88, s88, 114688
    v_mul_u32_u24 v39, 144, v1
    v_add_u32 v39, s88, v39
    v_mfma_f32_32x32x16_bf16 v[80:95], v[148:151], v[152:155], v[80:95]
    ds_read_b128 v[136:139], v25 offset:16384
    ds_read_b64_tr_b16 v[128:129], v14 offset:38912
    s_waitcnt lgkmcnt(8)
    v_mfma_f32_32x32x16_bf16 v[96:111], v[144:147], v[156:159], v[96:111]
    ds_read_b64_tr_b16 v[130:131], v14 offset:39424
    ds_read_b64_tr_b16 v[132:133], v15 offset:38912
    v_mfma_f32_32x32x16_bf16 v[112:127], v[148:151], v[156:159], v[112:127]
    ds_read_b64_tr_b16 v[134:135], v15 offset:39424
    ds_read_b128 v[140:143], v25 offset:20480
    buffer_load_dwordx2 v[240:241], v62, s[60:63], 0 offen sc1
    s_waitcnt lgkmcnt(7)
    v_mfma_f32_32x32x16_bf16 v[64:79], v[160:163], v[168:171], v[64:79]
    buffer_load_dwordx2 v[242:243], v62, s[60:63], 0 offen offset:1024 sc1
    v_mfma_f32_32x32x16_bf16 v[80:95], v[164:167], v[168:171], v[80:95]
    buffer_load_dwordx2 v[60:61], v63, s[60:63], 0 offen sc1
    s_waitcnt lgkmcnt(6)
    v_mfma_f32_32x32x16_bf16 v[96:111], v[160:163], v[172:175], v[96:111]
    v_mfma_f32_32x32x16_bf16 v[112:127], v[164:167], v[172:175], v[112:127]
    s_waitcnt lgkmcnt(0)
    v_mfma_f32_32x32x16_bf16 v[64:79], v[128:131], v[136:139], v[64:79]
    s_barrier
    v_mfma_f32_32x32x16_bf16 v[80:95], v[132:135], v[136:139], v[80:95]
    v_mfma_f32_32x32x16_bf16 v[96:111], v[128:131], v[140:143], v[96:111]
    v_mfma_f32_32x32x16_bf16 v[112:127], v[132:135], v[140:143], v[112:127]
    ds_read_b128 v[128:131], v32 offset:0
    ds_read_b128 v[132:135], v32 offset:4608
    ds_read_b128 v[136:139], v32 offset:9216
    ds_read_b128 v[140:143], v32 offset:13824
    ds_read_b128 v[144:147], v32 offset:18432
    ds_read_b128 v[148:151], v32 offset:23040
    ds_read_b128 v[152:155], v32 offset:27648
    ds_read_b128 v[156:159], v32 offset:32256
    v_lshlrev_b32 v249, 16, v31
    v_and_b32 v250, 0xffff0000, v31
    s_waitcnt lgkmcnt(4)
    v_add_f32 v128, v128, v132
    v_add_f32 v136, v136, v140
    v_add_f32 v129, v129, v133
    v_add_f32 v137, v137, v141
    v_add_f32 v130, v130, v134
    v_add_f32 v138, v138, v142
    v_add_f32 v131, v131, v135
    v_add_f32 v139, v139, v143
    v_add_f32 v128, v128, v249
    v_add_f32 v128, v128, v136
    v_add_f32 v129, v129, v137
    v_add_f32 v130, v130, v138
    v_add_f32 v131, v131, v139
    s_waitcnt lgkmcnt(0)
    v_add_f32 v144, v144, v148
    v_add_f32 v152, v152, v156
    v_add_f32 v145, v145, v149
    v_add_f32 v153, v153, v157
    v_add_f32 v146, v146, v150
    v_add_f32 v154, v154, v158
    v_add_f32 v147, v147, v151
    v_add_f32 v155, v155, v159
    v_add_f32 v144, v144, v250
    v_add_f32 v144, v144, v152
    v_add_f32 v145, v145, v153
    v_add_f32 v146, v146, v154
    v_add_f32 v147, v147, v155
    v_lshrrev_b32 v249, 3, v1
    v_lshrrev_b32 v250, 2, v249
    v_and_b32 v28, 3, v249
    v_lshl_add_u32 v28, v28, 1, v250
    s_lshr_b32 s88, s75, 2
    s_lshl_b32 s88, s88, 8
    s_and_b32 s89, s75, 3
    s_lshl_b32 s89, s89, 3
    s_add_u32 s88, s88, s89
    s_lshl_b32 s89, s70, 6
    s_add_u32 s88, s88, s89
    v_add_u32 v28, s88, v28
    v_mul_u32_u24 v28, 896, v28
    v_and_b32 v250, 7, v1
    v_lshl_add_u32 v28, v250, 4, v28
    s_lshl_b32 s88, s76, 7
    v_add_u32 v28, s88, v28
    v_mul_u32_u24 v29, 272, v249
    v_lshl_add_u32 v29, v250, 5, v29
    s_mul_i32 s88, s70, 4352
    v_add_u32 v29, s88, v29
    v_mul_u32_u24 v30, 144, v249
    v_lshl_add_u32 v30, v250, 4, v30
    s_mul_i32 s88, s70, 2304
    s_add_u32 s88, s88, 114688
    v_add_u32 v30, s88, v30
    s_mov_b32 s13, 28672
    buffer_load_dwordx4 v[168:171], v28, s[48:51], 0 offen
    buffer_load_dwordx4 v[172:175], v28, s[48:51], s13 offen
    s_waitcnt vmcnt(2)
    s_mov_b32 s94, 0
PAG_2:
    v_cmp_ne_u32 vcc, s68, v241
    v_cmp_ne_u32 s[90:91], s68, v243
    s_nop 0
    s_or_b64 vcc, vcc, s[90:91]
    v_cmp_ne_u32 s[90:91], s68, v61
    s_nop 0
    s_or_b64 vcc, vcc, s[90:91]
    s_cbranch_vccz POK_1
    s_add_u32 s94, s94, 1
    s_cmp_gt_u32 s94, 0x40000
    s_cbranch_scc1 POK_1
    s_sleep 2
    buffer_load_dwordx2 v[240:241], v62, s[60:63], 0 offen sc1
    buffer_load_dwordx2 v[242:243], v62, s[60:63], 0 offen offset:1024 sc1
    buffer_load_dwordx2 v[60:61], v63, s[60:63], 0 offen sc1
    s_waitcnt vmcnt(0)
    s_branch PAG_2
POK_1:
    v_and_b32 v40, 0xffff0000, v240
    v_rcp_f32 v41, v40
    v_and_b32 v43, 0xffff, v240
    v_xor_b32 v43, 0x8000, v43
    v_lshl_or_b32 v42, v43, 16, v43
    v_mul_f32 v41, 0xbfb8aa3b, v41
    v_and_b32 v44, 0xffff0000, v242
    v_rcp_f32 v45, v44
    v_and_b32 v47, 0xffff, v242
    v_xor_b32 v47, 0x8000, v47
    v_lshl_or_b32 v46, v47, 16, v47
    v_mul_f32 v45, 0xbfb8aa3b, v45
    s_mov_b32 vcc_lo, -1
    s_mov_b32 vcc_hi, 0
    v_and_b32 v148, 0xffff0000, v60
    v_sub_f32 v60, v60, v148
    v_and_b32 v149, 0xffff0000, v60
    v_sub_f32 v60, v60, v149
    v_cvt_pk_bf16_f32 v148, v148, v149
    v_cvt_pk_bf16_f32 v149, v60, 0
    v_mov_b32 v150, 0
    v_mov_b32 v151, 0
    v_cndmask_b32 v152, 0, v42, vcc
    v_cndmask_b32 v153, 0, v43, vcc
    v_mov_b32 v154, 0
    v_mov_b32 v155, 0
    v_cndmask_b32_e64 v156, v42, 0, vcc
    v_cndmask_b32_e64 v157, v43, 0, vcc
    v_mov_b32 v158, 0
    v_mov_b32 v159, 0
    v_cndmask_b32 v160, 0, v46, vcc
    v_cndmask_b32 v161, 0, v47, vcc
    v_mov_b32 v162, 0
    v_mov_b32 v163, 0
    v_cndmask_b32_e64 v164, v46, 0, vcc
    v_cndmask_b32_e64 v165, v47, 0, vcc
    v_mov_b32 v166, 0
    v_mov_b32 v167, 0
    v_mfma_f32_32x32x16_bf16 v[64:79], v[148:151], v[152:155], v[64:79]
    v_mfma_f32_32x32x16_bf16 v[80:95], v[148:151], v[156:159], v[80:95]
    v_mfma_f32_32x32x16_bf16 v[96:111], v[148:151], v[160:163], v[96:111]
    v_mfma_f32_32x32x16_bf16 v[112:127], v[148:151], v[164:167], v[112:127]
    s_setprio 3
    s_nop 7
    v_mul_f32 v64, v41, v64
    v_mul_f32 v65, v41, v65
    v_mul_f32 v66, v41, v66
    v_mul_f32 v67, v41, v67
    v_mul_f32 v68, v41, v68
    v_mul_f32 v69, v41, v69
    v_mul_f32 v70, v41, v70
    v_mul_f32 v71, v41, v71
    v_exp_f32 v64, v64
    v_exp_f32 v65, v65
    v_exp_f32 v66, v66
    v_exp_f32 v67, v67
    v_exp_f32 v68, v68
    v_exp_f32 v69, v69
    v_exp_f32 v70, v70
    v_exp_f32 v71, v71
    v_fma_f32 v64, v64, v40, v40
    v_fma_f32 v65, v65, v40, v40
    v_fma_f32 v66, v66, v40, v40
    v_fma_f32 v67, v67, v40, v40
    v_fma_f32 v68, v68, v40, v40
    v_fma_f32 v69, v69, v40, v40
    v_fma_f32 v70, v70, v40, v40
    v_fma_f32 v71, v71, v40, v40
    v_rcp_f32 v64, v64
    v_rcp_f32 v65, v65
    v_rcp_f32 v66, v66
    v_rcp_f32 v67, v67
    v_rcp_f32 v68, v68
    v_rcp_f32 v69, v69
    v_rcp_f32 v70, v70
    v_rcp_f32 v71, v71
    v_mul_f32 v72, v72, v64
    v_mul_f32 v73, v73, v65
    v_mul_f32 v74, v74, v66
    v_mul_f32 v75, v75, v67
    v_mul_f32 v76, v76, v68
    v_mul_f32 v77, v77, v69
    v_mul_f32 v78, v78, v70
    v_mul_f32 v79, v79, v71
    v_cvt_pk_bf16_f32 v64, v72, v73
    v_cvt_pk_bf16_f32 v65, v74, v75
    v_cvt_pk_bf16_f32 v66, v76, v77
    v_cvt_pk_bf16_f32 v67, v78, v79
    buffer_load_dword v251, v252, s[60:63], 0 offen offset:0 sc1
    buffer_store_dwordx4 v[64:67], v248, s[60:63], s95 offen offset:0 sc1
    v_mul_f32 v80, v41, v80
    v_mul_f32 v81, v41, v81
    v_mul_f32 v82, v41, v82
    v_mul_f32 v83, v41, v83
    v_mul_f32 v84, v41, v84
    v_mul_f32 v85, v41, v85
    v_mul_f32 v86, v41, v86
    v_mul_f32 v87, v41, v87
    v_exp_f32 v80, v80
    v_exp_f32 v81, v81
    v_exp_f32 v82, v82
    v_exp_f32 v83, v83
    v_exp_f32 v84, v84
    v_exp_f32 v85, v85
    v_exp_f32 v86, v86
    v_exp_f32 v87, v87
    v_fma_f32 v80, v80, v40, v40
    v_fma_f32 v81, v81, v40, v40
    v_fma_f32 v82, v82, v40, v40
    v_fma_f32 v83, v83, v40, v40
    v_fma_f32 v84, v84, v40, v40
    v_fma_f32 v85, v85, v40, v40
    v_fma_f32 v86, v86, v40, v40
    v_fma_f32 v87, v87, v40, v40
    v_rcp_f32 v80, v80
    v_rcp_f32 v81, v81
    v_rcp_f32 v82, v82
    v_rcp_f32 v83, v83
    v_rcp_f32 v84, v84
    v_rcp_f32 v85, v85
    v_rcp_f32 v86, v86
    v_rcp_f32 v87, v87
    v_mul_f32 v88, v88, v80
    v_mul_f32 v89, v89, v81
    v_mul_f32 v90, v90, v82
    v_mul_f32 v91, v91, v83
    v_mul_f32 v92, v92, v84
    v_mul_f32 v93, v93, v85
    v_mul_f32 v94, v94, v86
    v_mul_f32 v95, v95, v87
    v_cvt_pk_bf16_f32 v80, v88, v89
    v_cvt_pk_bf16_f32 v81, v90, v91
    v_cvt_pk_bf16_f32 v82, v92, v93
    v_cvt_pk_bf16_f32 v83, v94, v95
    buffer_store_dwordx4 v[80:83], v248, s[60:63], s95 offen offset:1024 sc1
    v_mul_f32 v96, v45, v96
    v_mul_f32 v97, v45, v97
    v_mul_f32 v98, v45, v98
    v_mul_f32 v99, v45, v99
    v_mul_f32 v100, v45, v100
    v_mul_f32 v101, v45, v101
    v_mul_f32 v102, v45, v102
    v_mul_f32 v103, v45, v103
    v_exp_f32 v96, v96
    v_exp_f32 v97, v97
    v_exp_f32 v98, v98
    v_exp_f32 v99, v99
    v_exp_f32 v100, v100
    v_exp_f32 v101, v101
    v_exp_f32 v102, v102
    s_cmp_eq_u32 s69, 3
    s_cbranch_scc1 L_7
    ds_write_b32 v12, v128 offset:42512
    ds_write_b32 v13, v129 offset:42512
    ds_write_b32 v16, v130 offset:42512
    ds_write_b32 v17, v131 offset:42512
    ds_write_b32 v12, v144 offset:45840
    ds_write_b32 v13, v145 offset:45840
    ds_write_b32 v16, v146 offset:45840
    ds_write_b32 v17, v147 offset:45840
    s_branch L_7_e
L_7:
    v_bfe_u32 v249, v1, 2, 1
    v_mul_u32_u24 v249, 3328, v249
    v_and_b32 v250, 3, v1
    v_lshl_add_u32 v249, v250, 2, v249
    v_mov_b32 v250, 0
    s_mov_b64 exec, 0xff
    ds_write_b32 v249, v250 offset:42496
    s_mov_b64 exec, -1
L_7_e:
    s_waitcnt lgkmcnt(0)
    s_barrier
    v_mov_b32 v34, 0
    v_mov_b32 v35, 0
    ds_write_b64 v33, v[34:35]
    s_waitcnt vmcnt(2)
    v_cmp_ne_u32 vcc, s68, v251
    s_mov_b32 s12, 1
    s_cbranch_vccnz L_ULATE
    s_mov_b32 s12, 0
    s_mul_i32 s89, s70, 4224
    s_add_u32 m0, s89, 18368
    s_nop 0
    buffer_load_dwordx4 v248, s[60:63], s11 offen offset:0 sc1 lds
    buffer_load_dwordx4 v248, s[60:63], s11 offen offset:1024 sc1 lds
    buffer_load_dwordx4 v248, s[60:63], s11 offen offset:2048 sc1 lds
    buffer_load_dwordx4 v248, s[60:63], s11 offen offset:3072 sc1 lds
L_ULATE:
    v_exp_f32 v103, v103
    v_fma_f32 v96, v96, v44, v44
    v_fma_f32 v97, v97, v44, v44
    v_fma_f32 v98, v98, v44, v44
    v_fma_f32 v99, v99, v44, v44
    v_fma_f32 v100, v100, v44, v44
    v_fma_f32 v101, v101, v44, v44
    v_fma_f32 v102, v102, v44, v44
    v_fma_f32 v103, v103, v44, v44
    v_rcp_f32 v96, v96
    v_rcp_f32 v97, v97
    v_rcp_f32 v98, v98
    v_rcp_f32 v99, v99
    v_rcp_f32 v100, v100
    v_rcp_f32 v101, v101
    v_rcp_f32 v102, v102
    v_rcp_f32 v103, v103
    v_mul_f32 v104, v104, v96
    v_mul_f32 v105, v105, v97
    v_mul_f32 v106, v106, v98
    v_mul_f32 v107, v107, v99
    v_mul_f32 v108, v108, v100
    v_mul_f32 v109, v109, v101
    v_mul_f32 v110, v110, v102
    v_mul_f32 v111, v111, v103
    v_cvt_pk_bf16_f32 v96, v104, v105
    v_cvt_pk_bf16_f32 v97, v106, v107
    v_cvt_pk_bf16_f32 v98, v108, v109
    v_cvt_pk_bf16_f32 v99, v110, v111
    buffer_store_dwordx4 v[96:99], v248, s[60:63], s10 offen offset:0 sc1
    v_mul_f32 v112, v45, v112
    v_mul_f32 v113, v45, v113
    v_mul_f32 v114, v45, v114
    v_mul_f32 v115, v45, v115
    v_mul_f32 v116, v45, v116
    v_mul_f32 v117, v45, v117
    v_mul_f32 v118, v45, v118
    v_mul_f32 v119, v45, v119
    v_exp_f32 v112, v112
    v_exp_f32 v113, v113
    v_exp_f32 v114, v114
    v_exp_f32 v115, v115
    v_exp_f32 v116, v116
    v_exp_f32 v117, v117
    v_exp_f32 v118, v118
    v_exp_f32 v119, v119
    v_fma_f32 v112, v112, v44, v44
    v_fma_f32 v113, v113, v44, v44
    v_fma_f32 v114, v114, v44, v44
    v_fma_f32 v115, v115, v44, v44
    v_fma_f32 v116, v116, v44, v44
    v_fma_f32 v117, v117, v44, v44
    v_fma_f32 v118, v118, v44, v44
    v_fma_f32 v119, v119, v44, v44
    v_rcp_f32 v112, v112
    v_rcp_f32 v113, v113
    v_rcp_f32 v114, v114
    v_rcp_f32 v115, v115
    v_rcp_f32 v116, v116
    v_rcp_f32 v117, v117
    v_rcp_f32 v118, v118
    v_rcp_f32 v119, v119
    v_mul_f32 v120, v120, v112
    v_mul_f32 v121, v121, v113
    v_mul_f32 v122, v122, v114
    v_mul_f32 v123, v123, v115
    v_mul_f32 v124, v124, v116
    v_mul_f32 v125, v125, v117
    v_mul_f32 v126, v126, v118
    v_mul_f32 v127, v127, v119
    v_cvt_pk_bf16_f32 v112, v120, v121
    v_cvt_pk_bf16_f32 v113, v122, v123
    v_cvt_pk_bf16_f32 v114, v124, v125
    v_cvt_pk_bf16_f32 v115, v126, v127
    buffer_load_dword v251, v252, s[60:63], 0 offen offset:0 sc1
    buffer_store_dwordx4 v[112:115], v248, s[60:63], s10 offen offset:1024 sc1
    s_setprio 3
    s_add_u32 m0, s8, 49152
    s_mul_i32 s87, s80, 229376
    buffer_load_dwordx4 v244, s[56:59], s87 offen offset:0 lds
    ds_read_b32 v128, v49 offset:42512
    ds_read_b32 v129, v50 offset:42512
    ds_read_b32 v130, v51 offset:42512
    ds_read_b32 v131, v52 offset:42512
    ds_read_b32 v132, v53 offset:42512
    ds_read_b32 v133, v54 offset:42512
    ds_read_b32 v134, v55 offset:42512
    ds_read_b32 v135, v56 offset:42512
    ds_read_b32 v136, v57 offset:42496
    ds_read_b32 v140, v49 offset:45840
    ds_read_b32 v141, v50 offset:45840
    buffer_load_dwordx4 v245, s[56:59], s87 offen offset:1024 lds
    ds_read_b32 v142, v51 offset:45840
    ds_read_b32 v143, v52 offset:45840
    ds_read_b32 v144, v53 offset:45840
    ds_read_b32 v145, v54 offset:45840
    ds_read_b32 v146, v55 offset:45840
    ds_read_b32 v147, v56 offset:45840
    ds_read_b32 v148, v57 offset:45824
    s_waitcnt lgkmcnt(10)
    buffer_load_dwordx4 v246, s[56:59], s87 offen offset:2048 lds
    v_cvt_pk_bf16_f32 v156, v128, v129
    v_cvt_pk_bf16_f32 v157, v130, v131
    v_cvt_pk_bf16_f32 v158, v132, v133
    v_cvt_pk_bf16_f32 v159, v134, v135
    ds_write_b128 v48, v[156:159] offset:4576
    buffer_load_dwordx4 v247, s[56:59], s87 offen offset:3072 lds
    s_waitcnt lgkmcnt(10)
    v_cvt_pk_bf16_f32 v152, v129, v130
    v_cvt_pk_bf16_f32 v153, v131, v132
    s_add_u32 m0, s8, 65536
    s_mul_i32 s87, s81, 229376
    buffer_load_dwordx4 v244, s[56:59], s87 offen offset:0 lds
    v_cvt_pk_bf16_f32 v154, v133, v134
    v_cvt_pk_bf16_f32 v155, v135, v136
    ds_write_b128 v48, v[152:155] offset:0
    s_waitcnt lgkmcnt(3)
    buffer_load_dwordx4 v245, s[56:59], s87 offen offset:1024 lds
    v_cvt_pk_bf16_f32 v164, v140, v141
    v_cvt_pk_bf16_f32 v165, v142, v143
    v_cvt_pk_bf16_f32 v166, v144, v145
    v_cvt_pk_bf16_f32 v167, v146, v147
    ds_write_b128 v48, v[164:167] offset:13728
    buffer_load_dwordx4 v246, s[56:59], s87 offen offset:2048 lds
    s_waitcnt lgkmcnt(3)
    buffer_load_dwordx4 v247, s[56:59], s87 offen offset:3072 lds
    v_cvt_pk_bf16_f32 v160, v141, v142
    v_cvt_pk_bf16_f32 v161, v143, v144
    v_cvt_pk_bf16_f32 v162, v145, v146
    v_cvt_pk_bf16_f32 v163, v147, v148
    ds_write_b128 v48, v[160:163] offset:9152
    s_waitcnt vmcnt(8)
    v_lshrrev_b32 v250, 5, v1
    v_mul_u32_u24 v250, 1920, v250
    v_lshl_add_u32 v249, v1, 2, v250
    v_mov_b32 v250, s68
    s_mov_b32 exec_lo, 0xff
    s_mov_b32 exec_hi, 0xff
    buffer_store_dword v250, v249, s[60:63], s96 offen offset:0 sc1
    s_mov_b64 exec, -1
    s_cmp_eq_u32 s12, 0
    s_cbranch_scc1 L_UDONE
    s_mov_b32 s94, 0
PAG_9:
    v_cmp_ne_u32 vcc, s68, v251
    s_cbranch_vccz POK_8
    s_add_u32 s94, s94, 1
    s_cmp_gt_u32 s94, 0x40000
    s_cbranch_scc1 POK_8
    s_sleep 2
    buffer_load_dword v251, v252, s[60:63], 0 offen offset:0 sc1
    s_waitcnt vmcnt(0)
    s_branch PAG_9
POK_8:
    s_mul_i32 s89, s70, 4224
    s_add_u32 m0, s89, 18368
    s_nop 0
    buffer_load_dwordx4 v248, s[60:63], s11 offen offset:0 sc1 lds
    buffer_load_dwordx4 v248, s[60:63], s11 offen offset:1024 sc1 lds
    buffer_load_dwordx4 v248, s[60:63], s11 offen offset:2048 sc1 lds
    buffer_load_dwordx4 v248, s[60:63], s11 offen offset:3072 sc1 lds
L_UDONE:
    s_add_u32 m0, s8, 81920
    s_mul_i32 s87, s82, 229376
    buffer_load_dwordx4 v244, s[56:59], s87 offen offset:0 lds
    s_lshl_b32 s88, s75, 1
    s_and_b32 s89, s70, 1
    buffer_load_dwordx4 v245, s[56:59], s87 offen offset:1024 lds
    s_add_u32 s88, s88, s89
    s_lshl_b32 s88, s88, 11
    buffer_load_dwordx4 v246, s[56:59], s87 offen offset:2048 lds
    s_add_u32 s88, s88, 3933184
    v_min_u32 v252, 13, v1
    buffer_load_dwordx4 v247, s[56:59], s87 offen offset:3072 lds
    v_lshl_add_u32 v252, v252, 5, s88
    s_barrier
    s_add_u32 m0, s8, 98304
    s_mul_i32 s87, s83, 229376
    buffer_load_dwordx4 v244, s[56:59], s87 offen offset:0 lds
    buffer_load_dwordx4 v245, s[56:59], s87 offen offset:1024 lds
    buffer_load_dwordx4 v246, s[56:59], s87 offen offset:2048 lds
    buffer_load_dwordx4 v247, s[56:59], s87 offen offset:3072 lds
    s_add_u32 m0, s8, 114688
    s_mul_i32 s87, s84, 229376
    buffer_load_dwordx4 v244, s[56:59], s87 offen offset:0 lds
    buffer_load_dwordx4 v245, s[56:59], s87 offen offset:1024 lds
    buffer_load_dwordx4 v246, s[56:59], s87 offen offset:2048 lds
    buffer_load_dwordx4 v247, s[56:59], s87 offen offset:3072 lds
    s_waitcnt vmcnt(12)
    s_waitcnt lgkmcnt(0)
    s_barrier
    s_setprio 0
    ds_read_b64 v[40:41], v27 offset:0
    ds_read_b64 v[42:43], v27 offset:8
    ds_read_b128 v[44:47], v26 offset:0
    ds_read_b128 v[48:51], v26 offset:512
    ds_read_b128 v[52:55], v26 offset:1024
    ds_read_b128 v[56:59], v26 offset:1536
    ds_read_b128 v[60:63], v26 offset:2048
    ds_read_b128 v[64:67], v26 offset:2560
    ds_read_b128 v[68:71], v26 offset:3072
    ds_read_b128 v[72:75], v26 offset:3584
    ds_read_b64 v[76:77], v27 offset:512
    ds_read_b64 v[78:79], v27 offset:520
    s_waitcnt lgkmcnt(9)
    v_mfma_f32_16x16x32_bf16 v[124:127], v[40:43], v[44:47], 0
    s_waitcnt lgkmcnt(8)
    v_mfma_f32_16x16x32_bf16 v[120:123], v[40:43], v[48:51], 0
    s_waitcnt lgkmcnt(7)
    v_mfma_f32_16x16x32_bf16 v[116:119], v[40:43], v[52:55], 0
    ds_read_b64 v[80:81], v27 offset:1024
    s_waitcnt lgkmcnt(7)
    v_mfma_f32_16x16x32_bf16 v[112:115], v[40:43], v[56:59], 0
    ds_read_b64 v[82:83], v27 offset:1032
    s_add_u32 m0, s8, 131072
    s_mul_i32 s87, s85, 229376
    buffer_load_dwordx4 v244, s[56:59], s87 offen offset:0 lds
    s_waitcnt lgkmcnt(7)
    v_mfma_f32_16x16x32_bf16 v[108:111], v[40:43], v[60:63], 0
    s_waitcnt lgkmcnt(6)
    v_mfma_f32_16x16x32_bf16 v[104:107], v[40:43], v[64:67], 0
    s_waitcnt lgkmcnt(5)
    v_mfma_f32_16x16x32_bf16 v[100:103], v[40:43], v[68:71], 0
    s_waitcnt lgkmcnt(4)
    v_mfma_f32_16x16x32_bf16 v[96:99], v[40:43], v[72:75], 0
    s_waitcnt lgkmcnt(2)
    v_mfma_f32_16x16x32_bf16 v[124:127], v[76:79], v[48:51], v[124:127]
    ds_read_b64 v[84:85], v27 offset:1536
    v_mfma_f32_16x16x32_bf16 v[120:123], v[76:79], v[52:55], v[120:123]
    ds_read_b64 v[86:87], v27 offset:1544
    v_mfma_f32_16x16x32_bf16 v[116:119], v[76:79], v[56:59], v[116:119]
    v_mfma_f32_16x16x32_bf16 v[112:115], v[76:79], v[60:63], v[112:115]
    buffer_load_dwordx4 v245, s[56:59], s87 offen offset:1024 lds
    v_mfma_f32_16x16x32_bf16 v[108:111], v[76:79], v[64:67], v[108:111]
    v_mfma_f32_16x16x32_bf16 v[104:107], v[76:79], v[68:71], v[104:107]
    ds_read_b64 v[88:89], v27 offset:2048
    v_mfma_f32_16x16x32_bf16 v[100:103], v[76:79], v[72:75], v[100:103]
    ds_read_b64 v[90:91], v27 offset:2056
    s_waitcnt lgkmcnt(4)
    v_mfma_f32_16x16x32_bf16 v[124:127], v[80:83], v[52:55], v[124:127]
    v_mfma_f32_16x16x32_bf16 v[120:123], v[80:83], v[56:59], v[120:123]
    v_mfma_f32_16x16x32_bf16 v[116:119], v[80:83], v[60:63], v[116:119]
    ds_read_b64 v[92:93], v27 offset:2560
    v_mfma_f32_16x16x32_bf16 v[112:115], v[80:83], v[64:67], v[112:115]
    ds_read_b64 v[94:95], v27 offset:2568
    v_mfma_f32_16x16x32_bf16 v[108:111], v[80:83], v[68:71], v[108:111]
    buffer_load_dwordx4 v246, s[56:59], s87 offen offset:2048 lds
    v_mfma_f32_16x16x32_bf16 v[104:107], v[80:83], v[72:75], v[104:107]
    ds_read_b64 v[128:129], v27 offset:3072
    s_waitcnt lgkmcnt(5)
    v_mfma_f32_16x16x32_bf16 v[124:127], v[84:87], v[56:59], v[124:127]
    ds_read_b64 v[130:131], v27 offset:3080
    v_mfma_f32_16x16x32_bf16 v[120:123], v[84:87], v[60:63], v[120:123]
    ds_read_b64 v[132:133], v27 offset:3584
    v_mfma_f32_16x16x32_bf16 v[116:119], v[84:87], v[64:67], v[116:119]
    ds_read_b64 v[134:135], v27 offset:3592
    v_mfma_f32_16x16x32_bf16 v[112:115], v[84:87], v[68:71], v[112:115]
    ds_read_b64 v[136:137], v27 offset:64
    v_mfma_f32_16x16x32_bf16 v[108:111], v[84:87], v[72:75], v[108:111]
    ds_read_b64 v[138:139], v27 offset:72
    s_waitcnt lgkmcnt(8)
    v_mfma_f32_16x16x32_bf16 v[124:127], v[88:91], v[60:63], v[124:127]
    ds_read_b128 v[140:143], v26 offset:64
    v_mfma_f32_16x16x32_bf16 v[120:123], v[88:91], v[64:67], v[120:123]
    ds_read_b128 v[144:147], v26 offset:576
    buffer_load_dwordx4 v247, s[56:59], s87 offen offset:3072 lds
    v_mfma_f32_16x16x32_bf16 v[116:119], v[88:91], v[68:71], v[116:119]
    ds_read_b128 v[148:151], v26 offset:1088
    v_mfma_f32_16x16x32_bf16 v[112:115], v[88:91], v[72:75], v[112:115]
    ds_read_b128 v[152:155], v26 offset:1600
    s_waitcnt lgkmcnt(10)
    v_mfma_f32_16x16x32_bf16 v[124:127], v[92:95], v[64:67], v[124:127]
    ds_read_b128 v[156:159], v26 offset:2112
    v_mfma_f32_16x16x32_bf16 v[120:123], v[92:95], v[68:71], v[120:123]
    ds_read_b128 v[160:163], v26 offset:2624
    v_mfma_f32_16x16x32_bf16 v[116:119], v[92:95], v[72:75], v[116:119]
    ds_read_b128 v[164:167], v26 offset:3136
    s_waitcnt lgkmcnt(11)
    v_mfma_f32_16x16x32_bf16 v[124:127], v[128:131], v[68:71], v[124:127]
    ds_read_b128 v[44:47], v26 offset:3648
    v_mfma_f32_16x16x32_bf16 v[120:123], v[128:131], v[72:75], v[120:123]
    ds_read_b64 v[40:41], v27 offset:576
    s_waitcnt lgkmcnt(11)
    v_mfma_f32_16x16x32_bf16 v[124:127], v[132:135], v[72:75], v[124:127]
    ds_read_b64 v[42:43], v27 offset:584
    s_add_u32 m0, s8, 147456
    s_mul_i32 s87, s86, 229376
    buffer_load_dwordx4 v244, s[56:59], s87 offen offset:0 lds
    s_waitcnt lgkmcnt(9)
    v_mfma_f32_16x16x32_bf16 v[124:127], v[136:139], v[140:143], v[124:127]
    s_waitcnt lgkmcnt(8)
    v_mfma_f32_16x16x32_bf16 v[120:123], v[136:139], v[144:147], v[120:123]
    s_waitcnt lgkmcnt(7)
    v_mfma_f32_16x16x32_bf16 v[116:119], v[136:139], v[148:151], v[116:119]
    ds_read_b64 v[48:49], v27 offset:1088
    s_waitcnt lgkmcnt(7)
    v_mfma_f32_16x16x32_bf16 v[112:115], v[136:139], v[152:155], v[112:115]
    ds_read_b64 v[50:51], v27 offset:1096
    s_waitcnt lgkmcnt(7)
    v_mfma_f32_16x16x32_bf16 v[108:111], v[136:139], v[156:159], v[108:111]
    s_waitcnt lgkmcnt(6)
    v_mfma_f32_16x16x32_bf16 v[104:107], v[136:139], v[160:163], v[104:107]
    s_waitcnt lgkmcnt(5)
    v_mfma_f32_16x16x32_bf16 v[100:103], v[136:139], v[164:167], v[100:103]
    s_waitcnt lgkmcnt(4)
    v_mfma_f32_16x16x32_bf16 v[96:99], v[136:139], v[44:47], v[96:99]
    buffer_load_dwordx4 v245, s[56:59], s87 offen offset:1024 lds
    s_waitcnt lgkmcnt(2)
    v_mfma_f32_16x16x32_bf16 v[124:127], v[40:43], v[144:147], v[124:127]
    ds_read_b64 v[76:77], v27 offset:1600
    v_mfma_f32_16x16x32_bf16 v[120:123], v[40:43], v[148:151], v[120:123]
    ds_read_b64 v[78:79], v27 offset:1608
    v_mfma_f32_16x16x32_bf16 v[116:119], v[40:43], v[152:155], v[116:119]
    v_mfma_f32_16x16x32_bf16 v[112:115], v[40:43], v[156:159], v[112:115]
    v_mfma_f32_16x16x32_bf16 v[108:111], v[40:43], v[160:163], v[108:111]
    v_mfma_f32_16x16x32_bf16 v[104:107], v[40:43], v[164:167], v[104:107]
    ds_read_b64 v[52:53], v27 offset:2112
    v_mfma_f32_16x16x32_bf16 v[100:103], v[40:43], v[44:47], v[100:103]
    ds_read_b64 v[54:55], v27 offset:2120
    s_waitcnt lgkmcnt(4)
    v_mfma_f32_16x16x32_bf16 v[124:127], v[48:51], v[148:151], v[124:127]
    buffer_load_dwordx4 v246, s[56:59], s87 offen offset:2048 lds
    v_mfma_f32_16x16x32_bf16 v[120:123], v[48:51], v[152:155], v[120:123]
    v_mfma_f32_16x16x32_bf16 v[116:119], v[48:51], v[156:159], v[116:119]
    ds_read_b64 v[80:81], v27 offset:2624
    v_mfma_f32_16x16x32_bf16 v[112:115], v[48:51], v[160:163], v[112:115]
    ds_read_b64 v[82:83], v27 offset:2632
    v_mfma_f32_16x16x32_bf16 v[108:111], v[48:51], v[164:167], v[108:111]
    v_mfma_f32_16x16x32_bf16 v[104:107], v[48:51], v[44:47], v[104:107]
    ds_read_b64 v[56:57], v27 offset:3136
    s_waitcnt lgkmcnt(5)
    v_mfma_f32_16x16x32_bf16 v[124:127], v[76:79], v[152:155], v[124:127]
    ds_read_b64 v[58:59], v27 offset:3144
    v_mfma_f32_16x16x32_bf16 v[120:123], v[76:79], v[156:159], v[120:123]
    ds_read_b64 v[84:85], v27 offset:3648
    v_mfma_f32_16x16x32_bf16 v[116:119], v[76:79], v[160:163], v[116:119]
    ds_read_b64 v[86:87], v27 offset:3656
    buffer_load_dwordx4 v247, s[56:59], s87 offen offset:3072 lds
    v_mfma_f32_16x16x32_bf16 v[112:115], v[76:79], v[164:167], v[112:115]
    ds_read_b64 v[60:61], v27 offset:128
    v_mfma_f32_16x16x32_bf16 v[108:111], v[76:79], v[44:47], v[108:111]
    ds_read_b64 v[62:63], v27 offset:136
    s_waitcnt lgkmcnt(8)
    v_mfma_f32_16x16x32_bf16 v[124:127], v[52:55], v[156:159], v[124:127]
    ds_read_b128 v[88:91], v26 offset:128
    v_mfma_f32_16x16x32_bf16 v[120:123], v[52:55], v[160:163], v[120:123]
    ds_read_b128 v[64:67], v26 offset:640
    v_mfma_f32_16x16x32_bf16 v[116:119], v[52:55], v[164:167], v[116:119]
    ds_read_b128 v[92:95], v26 offset:1152
    v_mfma_f32_16x16x32_bf16 v[112:115], v[52:55], v[44:47], v[112:115]
    ds_read_b128 v[68:71], v26 offset:1664
    s_waitcnt lgkmcnt(10)
    v_mfma_f32_16x16x32_bf16 v[124:127], v[80:83], v[160:163], v[124:127]
    ds_read_b128 v[128:131], v26 offset:2176
    v_mfma_f32_16x16x32_bf16 v[120:123], v[80:83], v[164:167], v[120:123]
    ds_read_b128 v[132:135], v26 offset:2688
    v_mfma_f32_16x16x32_bf16 v[116:119], v[80:83], v[44:47], v[116:119]
    ds_read_b128 v[72:75], v26 offset:3200
    s_waitcnt lgkmcnt(11)
    v_mfma_f32_16x16x32_bf16 v[124:127], v[56:59], v[164:167], v[124:127]
    ds_read_b128 v[140:143], v26 offset:3712
    v_mfma_f32_16x16x32_bf16 v[120:123], v[56:59], v[44:47], v[120:123]
    ds_read_b64 v[136:137], v27 offset:640
    s_waitcnt lgkmcnt(11)
    v_mfma_f32_16x16x32_bf16 v[124:127], v[84:87], v[44:47], v[124:127]
    ds_read_b64 v[138:139], v27 offset:648
    s_waitcnt lgkmcnt(9)
    v_mfma_f32_16x16x32_bf16 v[124:127], v[60:63], v[88:91], v[124:127]
    s_waitcnt lgkmcnt(8)
    v_mfma_f32_16x16x32_bf16 v[120:123], v[60:63], v[64:67], v[120:123]
    s_waitcnt lgkmcnt(7)
    v_mfma_f32_16x16x32_bf16 v[116:119], v[60:63], v[92:95], v[116:119]
    ds_read_b64 v[144:145], v27 offset:1152
    s_waitcnt lgkmcnt(7)
    v_mfma_f32_16x16x32_bf16 v[112:115], v[60:63], v[68:71], v[112:115]
    ds_read_b64 v[146:147], v27 offset:1160
    s_waitcnt lgkmcnt(7)
    v_mfma_f32_16x16x32_bf16 v[108:111], v[60:63], v[128:131], v[108:111]
    s_waitcnt lgkmcnt(6)
    v_mfma_f32_16x16x32_bf16 v[104:107], v[60:63], v[132:135], v[104:107]
    s_waitcnt lgkmcnt(5)
    v_mfma_f32_16x16x32_bf16 v[100:103], v[60:63], v[72:75], v[100:103]
    s_waitcnt lgkmcnt(4)
    v_mfma_f32_16x16x32_bf16 v[96:99], v[60:63], v[140:143], v[96:99]
    s_waitcnt lgkmcnt(2)
    v_mfma_f32_16x16x32_bf16 v[124:127], v[136:139], v[64:67], v[124:127]
    ds_read_b64 v[40:41], v27 offset:1664
    v_mfma_f32_16x16x32_bf16 v[120:123], v[136:139], v[92:95], v[120:123]
    ds_read_b64 v[42:43], v27 offset:1672
    v_mfma_f32_16x16x32_bf16 v[116:119], v[136:139], v[68:71], v[116:119]
    v_mfma_f32_16x16x32_bf16 v[112:115], v[136:139], v[128:131], v[112:115]
    v_mfma_f32_16x16x32_bf16 v[108:111], v[136:139], v[132:135], v[108:111]
    v_mfma_f32_16x16x32_bf16 v[104:107], v[136:139], v[72:75], v[104:107]
    ds_read_b64 v[148:149], v27 offset:2176
    v_mfma_f32_16x16x32_bf16 v[100:103], v[136:139], v[140:143], v[100:103]
    ds_read_b64 v[150:151], v27 offset:2184
    s_waitcnt lgkmcnt(4)
    v_mfma_f32_16x16x32_bf16 v[124:127], v[144:147], v[92:95], v[124:127]
    v_mfma_f32_16x16x32_bf16 v[120:123], v[144:147], v[68:71], v[120:123]
    v_mfma_f32_16x16x32_bf16 v[116:119], v[144:147], v[128:131], v[116:119]
    ds_read_b64 v[48:49], v27 offset:2688
    v_mfma_f32_16x16x32_bf16 v[112:115], v[144:147], v[132:135], v[112:115]
    ds_read_b64 v[50:51], v27 offset:2696
    v_mfma_f32_16x16x32_bf16 v[108:111], v[144:147], v[72:75], v[108:111]
    v_mfma_f32_16x16x32_bf16 v[104:107], v[144:147], v[140:143], v[104:107]
    ds_read_b64 v[152:153], v27 offset:3200
    s_waitcnt lgkmcnt(5)
    v_mfma_f32_16x16x32_bf16 v[124:127], v[40:43], v[68:71], v[124:127]
    ds_read_b64 v[154:155], v27 offset:3208
    v_mfma_f32_16x16x32_bf16 v[120:123], v[40:43], v[128:131], v[120:123]
    ds_read_b64 v[76:77], v27 offset:3712
    v_mfma_f32_16x16x32_bf16 v[116:119], v[40:43], v[132:135], v[116:119]
    ds_read_b64 v[78:79], v27 offset:3720
    v_mfma_f32_16x16x32_bf16 v[112:115], v[40:43], v[72:75], v[112:115]
    ds_read_b64 v[156:157], v27 offset:192
    v_mfma_f32_16x16x32_bf16 v[108:111], v[40:43], v[140:143], v[108:111]
    ds_read_b64 v[158:159], v27 offset:200
    s_waitcnt lgkmcnt(8)
    v_mfma_f32_16x16x32_bf16 v[124:127], v[148:151], v[128:131], v[124:127]
    ds_read_b128 v[52:55], v26 offset:192
    v_mfma_f32_16x16x32_bf16 v[120:123], v[148:151], v[132:135], v[120:123]
    ds_read_b128 v[160:163], v26 offset:704
    v_mfma_f32_16x16x32_bf16 v[116:119], v[148:151], v[72:75], v[116:119]
    ds_read_b128 v[80:83], v26 offset:1216
    v_mfma_f32_16x16x32_bf16 v[112:115], v[148:151], v[140:143], v[112:115]
    ds_read_b128 v[164:167], v26 offset:1728
    s_waitcnt lgkmcnt(10)
    v_mfma_f32_16x16x32_bf16 v[124:127], v[48:51], v[132:135], v[124:127]
    ds_read_b128 v[56:59], v26 offset:2240
    v_mfma_f32_16x16x32_bf16 v[120:123], v[48:51], v[72:75], v[120:123]
    ds_read_b128 v[84:87], v26 offset:2752
    v_mfma_f32_16x16x32_bf16 v[116:119], v[48:51], v[140:143], v[116:119]
    ds_read_b128 v[44:47], v26 offset:3264
    s_waitcnt lgkmcnt(11)
    v_mfma_f32_16x16x32_bf16 v[124:127], v[152:155], v[72:75], v[124:127]
    ds_read_b128 v[88:91], v26 offset:3776
    v_mfma_f32_16x16x32_bf16 v[120:123], v[152:155], v[140:143], v[120:123]
    ds_read_b64 v[60:61], v27 offset:704
    s_waitcnt lgkmcnt(11)
    v_mfma_f32_16x16x32_bf16 v[124:127], v[76:79], v[140:143], v[124:127]
    ds_read_b64 v[62:63], v27 offset:712
    s_waitcnt lgkmcnt(9)
    v_mfma_f32_16x16x32_bf16 v[124:127], v[156:159], v[52:55], v[124:127]
    s_waitcnt lgkmcnt(8)
    v_mfma_f32_16x16x32_bf16 v[120:123], v[156:159], v[160:163], v[120:123]
    s_waitcnt lgkmcnt(7)
    v_mfma_f32_16x16x32_bf16 v[116:119], v[156:159], v[80:83], v[116:119]
    ds_read_b64 v[64:65], v27 offset:1216
    s_waitcnt lgkmcnt(7)
    v_mfma_f32_16x16x32_bf16 v[112:115], v[156:159], v[164:167], v[112:115]
    ds_read_b64 v[66:67], v27 offset:1224
    s_waitcnt lgkmcnt(7)
    v_mfma_f32_16x16x32_bf16 v[108:111], v[156:159], v[56:59], v[108:111]
    s_waitcnt lgkmcnt(6)
    v_mfma_f32_16x16x32_bf16 v[104:107], v[156:159], v[84:87], v[104:107]
    s_waitcnt lgkmcnt(5)
    v_mfma_f32_16x16x32_bf16 v[100:103], v[156:159], v[44:47], v[100:103]
    s_waitcnt lgkmcnt(4)
    v_mfma_f32_16x16x32_bf16 v[96:99], v[156:159], v[88:91], v[96:99]
    s_waitcnt lgkmcnt(2)
    v_mfma_f32_16x16x32_bf16 v[124:127], v[60:63], v[160:163], v[124:127]
    ds_read_b64 v[136:137], v27 offset:1728
    v_mfma_f32_16x16x32_bf16 v[120:123], v[60:63], v[80:83], v[120:123]
    ds_read_b64 v[138:139], v27 offset:1736
    v_mfma_f32_16x16x32_bf16 v[116:119], v[60:63], v[164:167], v[116:119]
    v_mfma_f32_16x16x32_bf16 v[112:115], v[60:63], v[56:59], v[112:115]
    v_mfma_f32_16x16x32_bf16 v[108:111], v[60:63], v[84:87], v[108:111]
    v_mfma_f32_16x16x32_bf16 v[104:107], v[60:63], v[44:47], v[104:107]
    ds_read_b64 v[92:93], v27 offset:2240
    v_mfma_f32_16x16x32_bf16 v[100:103], v[60:63], v[88:91], v[100:103]
    ds_read_b64 v[94:95], v27 offset:2248
    s_waitcnt lgkmcnt(4)
    v_mfma_f32_16x16x32_bf16 v[124:127], v[64:67], v[80:83], v[124:127]
    v_mfma_f32_16x16x32_bf16 v[120:123], v[64:67], v[164:167], v[120:123]
    v_mfma_f32_16x16x32_bf16 v[116:119], v[64:67], v[56:59], v[116:119]
    ds_read_b64 v[144:145], v27 offset:2752
    v_mfma_f32_16x16x32_bf16 v[112:115], v[64:67], v[84:87], v[112:115]
    ds_read_b64 v[146:147], v27 offset:2760
    v_mfma_f32_16x16x32_bf16 v[108:111], v[64:67], v[44:47], v[108:111]
    v_mfma_f32_16x16x32_bf16 v[104:107], v[64:67], v[88:91], v[104:107]
    ds_read_b64 v[68:69], v27 offset:3264
    s_waitcnt lgkmcnt(5)
    v_mfma_f32_16x16x32_bf16 v[124:127], v[136:139], v[164:167], v[124:127]
    ds_read_b64 v[70:71], v27 offset:3272
    v_mfma_f32_16x16x32_bf16 v[120:123], v[136:139], v[56:59], v[120:123]
    ds_read_b64 v[40:41], v27 offset:3776
    v_mfma_f32_16x16x32_bf16 v[116:119], v[136:139], v[84:87], v[116:119]
    ds_read_b64 v[42:43], v27 offset:3784
    v_mfma_f32_16x16x32_bf16 v[112:115], v[136:139], v[44:47], v[112:115]
    v_mfma_f32_16x16x32_bf16 v[108:111], v[136:139], v[88:91], v[108:111]
    s_waitcnt lgkmcnt(6)
    v_mfma_f32_16x16x32_bf16 v[124:127], v[92:95], v[56:59], v[124:127]
    v_mfma_f32_16x16x32_bf16 v[120:123], v[92:95], v[84:87], v[120:123]
    v_mfma_f32_16x16x32_bf16 v[116:119], v[92:95], v[44:47], v[116:119]
    v_mfma_f32_16x16x32_bf16 v[112:115], v[92:95], v[88:91], v[112:115]
    s_waitcnt lgkmcnt(4)
    v_mfma_f32_16x16x32_bf16 v[124:127], v[144:147], v[84:87], v[124:127]
    v_mfma_f32_16x16x32_bf16 v[120:123], v[144:147], v[44:47], v[120:123]
    v_mfma_f32_16x16x32_bf16 v[116:119], v[144:147], v[88:91], v[116:119]
    s_waitcnt lgkmcnt(2)
    v_mfma_f32_16x16x32_bf16 v[124:127], v[68:71], v[44:47], v[124:127]
    v_mfma_f32_16x16x32_bf16 v[120:123], v[68:71], v[88:91], v[120:123]
    s_waitcnt lgkmcnt(0)
    v_mfma_f32_16x16x32_bf16 v[124:127], v[40:43], v[88:91], v[124:127]
    s_waitcnt vmcnt(0)
    s_barrier
    s_setprio 3
    v_add_u32 v10, s8, v248
    v_xor_b32 v11, 4096, v10
    s_and_b32 s88, s70, 1
    s_cmp_eq_u32 s88, 1
    s_cbranch_scc1 L_X1
    ds_write_b128 v11, v[112:115] offset:32768
    ds_write_b128 v11, v[116:119] offset:33792
    ds_write_b128 v11, v[120:123] offset:34816
    ds_write_b128 v11, v[124:127] offset:35840
    s_branch L_XE
L_X1:
    ds_write_b128 v11, v[96:99] offset:32768
    ds_write_b128 v11, v[100:103] offset:33792
    ds_write_b128 v11, v[104:107] offset:34816
    ds_write_b128 v11, v[108:111] offset:35840
    v_mov_b32 v96, v112
    v_mov_b32 v97, v113
    v_mov_b32 v98, v114
    v_mov_b32 v99, v115
    v_mov_b32 v100, v116
    v_mov_b32 v101, v117
    v_mov_b32 v102, v118
    v_mov_b32 v103, v119
    v_mov_b32 v104, v120
    v_mov_b32 v105, v121
    v_mov_b32 v106, v122
    v_mov_b32 v107, v123
    v_mov_b32 v108, v124
    v_mov_b32 v109, v125
    v_mov_b32 v110, v126
    v_mov_b32 v111, v127
L_XE:
    s_waitcnt lgkmcnt(0)
    s_barrier
    ds_read_b128 v[112:115], v10 offset:32768
    ds_read_b128 v[116:119], v10 offset:33792
    ds_read_b128 v[120:123], v10 offset:34816
    ds_read_b128 v[124:127], v10 offset:35840
    v_lshlrev_b32 v12, 3, v1
    v_add_u32 v11, 49152, v10
    s_waitcnt lgkmcnt(3)
    v_add_f32 v96, v96, v112
    v_add_f32 v97, v97, v113
    v_add_f32 v98, v98, v114
    v_add_f32 v99, v99, v115
    v_cvt_pk_bf16_f32 v96, v96, v97
    v_cvt_pk_bf16_f32 v97, v98, v99
    buffer_store_dwordx2 v[96:97], v12, s[60:63], s6 offen offset:0 sc1
    s_waitcnt lgkmcnt(2)
    v_add_f32 v100, v100, v116
    v_add_f32 v101, v101, v117
    v_add_f32 v102, v102, v118
    v_add_f32 v103, v103, v119
    v_cvt_pk_bf16_f32 v100, v100, v101
    v_cvt_pk_bf16_f32 v101, v102, v103
    buffer_store_dwordx2 v[100:101], v12, s[60:63], s6 offen offset:512 sc1
    s_waitcnt lgkmcnt(1)
    v_add_f32 v104, v104, v120
    v_add_f32 v105, v105, v121
    v_add_f32 v106, v106, v122
    v_add_f32 v107, v107, v123
    v_cvt_pk_bf16_f32 v104, v104, v105
    v_cvt_pk_bf16_f32 v105, v106, v107
    buffer_store_dwordx2 v[104:105], v12, s[60:63], s6 offen offset:1024 sc1
    s_waitcnt lgkmcnt(0)
    v_add_f32 v108, v108, v124
    v_add_f32 v109, v109, v125
    v_add_f32 v110, v110, v126
    v_add_f32 v111, v111, v127
    v_cvt_pk_bf16_f32 v108, v108, v109
    v_cvt_pk_bf16_f32 v109, v110, v111
    buffer_store_dwordx2 v[108:109], v12, s[60:63], s6 offen offset:1536 sc1
    s_setprio 0
    buffer_load_dword v251, v252, s[60:63], 0 offen offset:0 sc1
    s_add_u32 m0, s8, 0
    s_mul_i32 s87, s80, 229376
    s_add_u32 s87, s87, 57344
    buffer_load_dwordx4 v244, s[56:59], s87 offen offset:0 lds
    buffer_load_dwordx4 v245, s[56:59], s87 offen offset:1024 lds
    buffer_load_dwordx4 v246, s[56:59], s87 offen offset:2048 lds
    buffer_load_dwordx4 v247, s[56:59], s87 offen offset:3072 lds
    s_add_u32 m0, s8, 16384
    s_mul_i32 s87, s81, 229376
    s_add_u32 s87, s87, 57344
    buffer_load_dwordx4 v244, s[56:59], s87 offen offset:0 lds
    s_waitcnt vmcnt(6)
    s_setprio 3
    v_lshrrev_b32 v250, 5, v1
    v_mul_u32_u24 v250, 1920, v250
    v_lshl_add_u32 v249, v1, 2, v250
    v_mov_b32 v250, s68
    s_mov_b32 exec_lo, 0xff
    s_mov_b32 exec_hi, 0
    buffer_store_dword v250, v249, s[60:63], s7 offen offset:0 sc1
    s_mov_b64 exec, -1
    s_setprio 0
    buffer_load_dwordx4 v245, s[56:59], s87 offen offset:1024 lds
    buffer_load_dwordx4 v246, s[56:59], s87 offen offset:2048 lds
    buffer_load_dwordx4 v247, s[56:59], s87 offen offset:3072 lds
    s_add_u32 m0, s8, 32768
    s_mul_i32 s87, s82, 229376
    s_add_u32 s87, s87, 57344
    buffer_load_dwordx4 v244, s[56:59], s87 offen offset:0 lds
    buffer_load_dwordx4 v245, s[56:59], s87 offen offset:1024 lds
    buffer_load_dwordx4 v246, s[56:59], s87 offen offset:2048 lds
    buffer_load_dwordx4 v247, s[56:59], s87 offen offset:3072 lds
    s_waitcnt vmcnt(13)
    s_mov_b32 s94, 0
PAG_13:
    v_cmp_ne_u32 vcc, s68, v251
    s_cbranch_vccz POK_12
    s_add_u32 s94, s94, 1
    s_cmp_gt_u32 s94, 0x40000
    s_cbranch_scc1 POK_12
    s_sleep 2
    buffer_load_dword v251, v252, s[60:63], 0 offen offset:0 sc1
    s_waitcnt vmcnt(0)
    s_branch PAG_13
POK_12:
    s_barrier
    s_setprio 0
    ds_write_b128 v11, v[176:179] offset:0
    ds_write_b128 v11, v[180:183] offset:1024
    ds_write_b128 v11, v[184:187] offset:2048
    ds_write_b128 v11, v[188:191] offset:3072
    ds_write_b128 v11, v[192:195] offset:16384
    ds_write_b128 v11, v[196:199] offset:17408
    ds_write_b128 v11, v[200:203] offset:18432
    ds_write_b128 v11, v[204:207] offset:19456
    s_waitcnt vmcnt(0)
    s_barrier
    ds_write_b128 v11, v[208:211] offset:32768
    ds_write_b128 v11, v[212:215] offset:33792
    s_setprio 3
    buffer_load_dword v251, v37, s[60:63], 0 offen sc1
    s_setprio 0
    ds_write_b128 v11, v[216:219] offset:34816
    ds_write_b128 v11, v[220:223] offset:35840
    ds_write_b128 v11, v[224:227] offset:49152
    ds_write_b128 v11, v[228:231] offset:50176
    ds_write_b128 v11, v[232:235] offset:51200
    ds_write_b128 v11, v[236:239] offset:52224
    s_setprio 3
    s_waitcnt lgkmcnt(0)
    s_barrier
    s_waitcnt vmcnt(0)
    s_mov_b32 s94, 0
PAG_15:
    v_cmp_ne_u32 vcc, s68, v251
    s_cbranch_vccz POK_14
    s_add_u32 s94, s94, 1
    s_cmp_gt_u32 s94, 0x40000
    s_cbranch_scc1 POK_14
    s_sleep 2
    buffer_load_dword v251, v37, s[60:63], 0 offen sc1
    s_waitcnt vmcnt(0)
    s_branch PAG_15
POK_14:
    s_lshl_b32 s88, s70, 11
    s_add_u32 m0, s88, 131072
    s_mov_b32 s88, 31744
    buffer_load_dwordx4 v36, s[60:63], 0 offen sc1 lds
    buffer_load_dwordx4 v36, s[60:63], s88 offen offset:1024 sc1 lds
    s_waitcnt vmcnt(0)
    ds_read_b64_tr_b16 v[48:49], v38 offset:0
    ds_read_b64_tr_b16 v[50:51], v38 offset:512
    ds_read_b64_tr_b16 v[52:53], v38 offset:1024
    ds_read_b64_tr_b16 v[54:55], v38 offset:1536
    s_waitcnt lgkmcnt(0)
    ds_write_b128 v39, v[48:51] offset:0
    ds_write_b128 v39, v[52:55] offset:16
    s_waitcnt lgkmcnt(0)
    s_barrier
    ds_read_b128 v[152:155], v30 offset:0
    ds_read_b128 v[156:159], v30 offset:1152
    v_lshlrev_b32 v136, 16, v168
    v_and_b32 v137, 0xffff0000, v168
    v_lshlrev_b32 v138, 16, v169
    v_and_b32 v139, 0xffff0000, v169
    v_lshlrev_b32 v140, 16, v170
    v_and_b32 v141, 0xffff0000, v170
    v_lshlrev_b32 v142, 16, v171
    v_and_b32 v143, 0xffff0000, v171
    v_lshlrev_b32 v144, 16, v172
    v_and_b32 v145, 0xffff0000, v172
    v_lshlrev_b32 v146, 16, v173
    v_and_b32 v147, 0xffff0000, v173
    v_lshlrev_b32 v148, 16, v174
    v_and_b32 v149, 0xffff0000, v174
    v_lshlrev_b32 v150, 16, v175
    v_and_b32 v151, 0xffff0000, v175
    s_waitcnt lgkmcnt(0)
    v_lshlrev_b32 v160, 16, v152
    v_and_b32 v161, 0xffff0000, v152
    v_add_f32 v136, v136, v160
    v_add_f32 v137, v137, v161
    v_lshlrev_b32 v160, 16, v153
    v_and_b32 v161, 0xffff0000, v153
    v_add_f32 v138, v138, v160
    v_add_f32 v139, v139, v161
    v_lshlrev_b32 v160, 16, v154
    v_and_b32 v161, 0xffff0000, v154
    v_add_f32 v140, v140, v160
    v_add_f32 v141, v141, v161
    v_lshlrev_b32 v160, 16, v155
    v_and_b32 v161, 0xffff0000, v155
    v_add_f32 v142, v142, v160
    v_add_f32 v143, v143, v161
    v_lshlrev_b32 v160, 16, v156
    v_and_b32 v161, 0xffff0000, v156
    v_add_f32 v144, v144, v160
    v_add_f32 v145, v145, v161
    v_lshlrev_b32 v160, 16, v157
    v_and_b32 v161, 0xffff0000, v157
    v_add_f32 v146, v146, v160
    v_add_f32 v147, v147, v161
    v_lshlrev_b32 v160, 16, v158
    v_and_b32 v161, 0xffff0000, v158
    v_add_f32 v148, v148, v160
    v_add_f32 v149, v149, v161
    v_lshlrev_b32 v160, 16, v159
    v_and_b32 v161, 0xffff0000, v159
    v_add_f32 v150, v150, v160
    v_add_f32 v151, v151, v161
    s_barrier
    ds_read_b128 v[96:99], v29 offset:0
    ds_read_b128 v[100:103], v29 offset:16
    ds_read_b128 v[104:107], v29 offset:17408
    ds_read_b128 v[108:111], v29 offset:17424
    ds_read_b128 v[112:115], v29 offset:2176
    ds_read_b128 v[116:119], v29 offset:2192
    ds_read_b128 v[120:123], v29 offset:19584
    ds_read_b128 v[124:127], v29 offset:19600
    s_waitcnt lgkmcnt(7)
    v_pk_add_f32 v[136:137], v[136:137], v[96:97]
    v_pk_add_f32 v[138:139], v[138:139], v[98:99]
    s_waitcnt lgkmcnt(6)
    v_pk_add_f32 v[140:141], v[140:141], v[100:101]
    v_pk_add_f32 v[142:143], v[142:143], v[102:103]
    s_waitcnt lgkmcnt(5)
    v_pk_add_f32 v[136:137], v[136:137], v[104:105]
    v_pk_add_f32 v[138:139], v[138:139], v[106:107]
    s_waitcnt lgkmcnt(4)
    v_pk_add_f32 v[140:141], v[140:141], v[108:109]
    v_pk_add_f32 v[142:143], v[142:143], v[110:111]
    v_cvt_pk_bf16_f32 v168, v136, v137
    v_cvt_pk_bf16_f32 v169, v138, v139
    v_cvt_pk_bf16_f32 v170, v140, v141
    v_cvt_pk_bf16_f32 v171, v142, v143
    buffer_store_dwordx4 v[168:171], v28, s[64:67], 0 offen
    s_waitcnt lgkmcnt(3)
    v_pk_add_f32 v[144:145], v[144:145], v[112:113]
    v_pk_add_f32 v[146:147], v[146:147], v[114:115]
    s_waitcnt lgkmcnt(2)
    v_pk_add_f32 v[148:149], v[148:149], v[116:117]
    v_pk_add_f32 v[150:151], v[150:151], v[118:119]
    s_waitcnt lgkmcnt(1)
    v_pk_add_f32 v[144:145], v[144:145], v[120:121]
    v_pk_add_f32 v[146:147], v[146:147], v[122:123]
    s_waitcnt lgkmcnt(0)
    v_pk_add_f32 v[148:149], v[148:149], v[124:125]
    v_pk_add_f32 v[150:151], v[150:151], v[126:127]
    v_cvt_pk_bf16_f32 v172, v144, v145
    v_cvt_pk_bf16_f32 v173, v146, v147
    v_cvt_pk_bf16_f32 v174, v148, v149
    v_cvt_pk_bf16_f32 v175, v150, v151
    buffer_store_dwordx4 v[172:175], v28, s[64:67], s13 offen
    s_endpgm
L_B:
    s_setprio 1
    v_bfe_u32 v249, v1, 4, 1
    s_and_b32 s88, s70, 2
    v_or_b32 v249, s88, v249
    v_lshlrev_b32 v249, 1, v249
    v_and_b32 v250, 7, v1
    v_xor_b32 v250, v250, v249
    s_and_b32 s88, s70, 1
    s_mul_i32 s89, s88, 114688
    s_lshl_b32 s90, s74, 8
    s_add_u32 s89, s89, s90
    v_lshrrev_b32 v249, 3, v1
    v_mul_u32_u24 v6, 3584, v249
    v_lshl_add_u32 v6, v250, 4, v6
    v_add_u32 v6, s89, v6
    v_add_u32 v7, 27648, v6
    v_add_u32 v8, 55296, v6
    v_add_u32 v9, 82944, v6
    s_add_u32 m0, s8, 65536
    s_mul_i32 s87, s80, 229376
    buffer_load_dwordx4 v6, s[52:55], s87 offen offset:0 lds
    buffer_load_dwordx4 v7, s[52:55], s87 offen offset:1024 lds
    buffer_load_dwordx4 v8, s[52:55], s87 offen offset:2048 lds
    buffer_load_dwordx4 v9, s[52:55], s87 offen offset:3072 lds
    v_and_b32 v249, 15, v1
    v_lshrrev_b32 v250, 4, v1
    v_mul_u32_u24 v34, 288, v249
    v_lshl_add_u32 v34, v250, 4, v34
    v_add_u32 v34, s79, v34
    v_lshrrev_b32 v249, 5, v1
    v_bfe_u32 v250, v1, 3, 2
    v_lshl_add_u32 v249, v250, 1, v249
    v_add_u32 v249, s77, v249
    v_mul_u32_u24 v2, 896, v249
    v_lshrrev_b32 v249, 4, v1
    v_and_b32 v250, 7, v1
    v_xor_b32 v250, v250, v249
    v_lshl_add_u32 v2, v250, 4, v2
    v_xor_b32 v3, 64, v2
    v_add_u32 v4, 55296, v2
    v_add_u32 v5, 82944, v3
    v_add_u32 v3, 27648, v3
    s_waitcnt lgkmcnt(0)
    s_mul_i32 s68, s68, 0x19660d
    s_add_u32 s68, s68, 0x3c6ef35f
    s_mov_b32 m0, s79
    s_waitcnt vmcnt(9)
    v_lshlrev_b32 v46, 16, v46
    v_lshlrev_b32 v40, 16, v40
    v_lshlrev_b32 v41, 16, v41
    s_mov_b32 s88, 0x3fb8aa3b
    v_mul_f32 v36, s88, v46
    v_fma_f32 v37, v46, s88, -v36
    v_exp_f32 v36, v36
    v_fmac_f32 v37, 0x32a57060, v46
    v_mul_f32 v37, 0x3f317218, v37
    v_fma_f32 v47, v36, v37, v36
    v_cvt_pk_bf16_f32 v47, v47, v47
    v_lshlrev_b32 v47, 16, v47
    v_mul_f32 v48, v47, v40
    v_mul_f32 v49, v47, v41
    v_mul_f32 v48, s88, v48
    v_mul_f32 v49, 0x3e22f983, v49
    v_mul_f32 v36, 0x41000000, v48
    v_mul_f32 v37, 0x41000000, v49
    v_fract_f32 v37, v37
    v_exp_f32 v36, v36
    v_cos_f32 v52, v37
    v_sin_f32 v53, v37
    s_nop 0
    v_pk_mul_f32 v[52:53], v[52:53], v[36:37] op_sel_hi:[1,0]
    v_mov_b32 v71, 0x3f80
    ds_write_addtid_b32 v71 offset:0
    v_cvt_pk_bf16_f32 v68, v52, v53
    ds_write_addtid_b32 v68 offset:288
    v_pk_mul_f32 v[64:65], v[52:53], v[52:53] op_sel:[0,0] op_sel_hi:[0,1]
    v_pk_fma_f32 v[60:61], v[52:53], v[52:53], v[64:65] op_sel:[1,1,0] op_sel_hi:[1,0,1] neg_lo:[1,0,0]
    v_cvt_pk_bf16_f32 v69, v60, v61
    ds_write_addtid_b32 v69 offset:576
    v_pk_mul_f32 v[64:65], v[60:61], v[52:53] op_sel:[0,0] op_sel_hi:[0,1]
    v_pk_fma_f32 v[60:61], v[60:61], v[52:53], v[64:65] op_sel:[1,1,0] op_sel_hi:[1,0,1] neg_lo:[1,0,0]
    v_cvt_pk_bf16_f32 v70, v60, v61
    ds_write_addtid_b32 v70 offset:864
    v_pk_mul_f32 v[64:65], v[60:61], v[52:53] op_sel:[0,0] op_sel_hi:[0,1]
    v_pk_fma_f32 v[60:61], v[60:61], v[52:53], v[64:65] op_sel:[1,1,0] op_sel_hi:[1,0,1] neg_lo:[1,0,0]
    v_cvt_pk_bf16_f32 v71, v60, v61
    ds_write_addtid_b32 v71 offset:1152
    v_pk_mul_f32 v[64:65], v[60:61], v[52:53] op_sel:[0,0] op_sel_hi:[0,1]
    v_pk_fma_f32 v[60:61], v[60:61], v[52:53], v[64:65] op_sel:[1,1,0] op_sel_hi:[1,0,1] neg_lo:[1,0,0]
    v_cvt_pk_bf16_f32 v68, v60, v61
    ds_write_addtid_b32 v68 offset:1440
    v_pk_mul_f32 v[64:65], v[60:61], v[52:53] op_sel:[0,0] op_sel_hi:[0,1]
    v_pk_fma_f32 v[60:61], v[60:61], v[52:53], v[64:65] op_sel:[1,1,0] op_sel_hi:[1,0,1] neg_lo:[1,0,0]
    v_cvt_pk_bf16_f32 v69, v60, v61
    ds_write_addtid_b32 v69 offset:1728
    v_pk_mul_f32 v[64:65], v[60:61], v[52:53] op_sel:[0,0] op_sel_hi:[0,1]
    v_pk_fma_f32 v[60:61], v[60:61], v[52:53], v[64:65] op_sel:[1,1,0] op_sel_hi:[1,0,1] neg_lo:[1,0,0]
    v_cvt_pk_bf16_f32 v70, v60, v61
    ds_write_addtid_b32 v70 offset:2016
    v_pk_mul_f32 v[64:65], v[60:61], v[52:53] op_sel:[0,0] op_sel_hi:[0,1]
    v_pk_fma_f32 v[60:61], v[60:61], v[52:53], v[64:65] op_sel:[1,1,0] op_sel_hi:[1,0,1] neg_lo:[1,0,0]
    v_cvt_pk_bf16_f32 v71, v60, v61
    ds_write_addtid_b32 v71 offset:2304
    v_pk_mul_f32 v[64:65], v[60:61], v[52:53] op_sel:[0,0] op_sel_hi:[0,1]
    v_pk_fma_f32 v[60:61], v[60:61], v[52:53], v[64:65] op_sel:[1,1,0] op_sel_hi:[1,0,1] neg_lo:[1,0,0]
    v_cvt_pk_bf16_f32 v68, v60, v61
    ds_write_addtid_b32 v68 offset:2592
    v_pk_mul_f32 v[64:65], v[60:61], v[52:53] op_sel:[0,0] op_sel_hi:[0,1]
    v_pk_fma_f32 v[60:61], v[60:61], v[52:53], v[64:65] op_sel:[1,1,0] op_sel_hi:[1,0,1] neg_lo:[1,0,0]
    v_cvt_pk_bf16_f32 v69, v60, v61
    ds_write_addtid_b32 v69 offset:2880
    v_pk_mul_f32 v[64:65], v[60:61], v[52:53] op_sel:[0,0] op_sel_hi:[0,1]
    v_pk_fma_f32 v[60:61], v[60:61], v[52:53], v[64:65] op_sel:[1,1,0] op_sel_hi:[1,0,1] neg_lo:[1,0,0]
    v_cvt_pk_bf16_f32 v70, v60, v61
    ds_write_addtid_b32 v70 offset:3168
    v_pk_mul_f32 v[64:65], v[60:61], v[52:53] op_sel:[0,0] op_sel_hi:[0,1]
    v_pk_fma_f32 v[60:61], v[60:61], v[52:53], v[64:65] op_sel:[1,1,0] op_sel_hi:[1,0,1] neg_lo:[1,0,0]
    v_cvt_pk_bf16_f32 v71, v60, v61
    ds_write_addtid_b32 v71 offset:3456
    v_pk_mul_f32 v[64:65], v[60:61], v[52:53] op_sel:[0,0] op_sel_hi:[0,1]
    v_pk_fma_f32 v[60:61], v[60:61], v[52:53], v[64:65] op_sel:[1,1,0] op_sel_hi:[1,0,1] neg_lo:[1,0,0]
    v_cvt_pk_bf16_f32 v68, v60, v61
    ds_write_addtid_b32 v68 offset:3744
    v_pk_mul_f32 v[64:65], v[60:61], v[52:53] op_sel:[0,0] op_sel_hi:[0,1]
    v_pk_fma_f32 v[60:61], v[60:61], v[52:53], v[64:65] op_sel:[1,1,0] op_sel_hi:[1,0,1] neg_lo:[1,0,0]
    v_cvt_pk_bf16_f32 v69, v60, v61
    ds_write_addtid_b32 v69 offset:4032
    v_pk_mul_f32 v[64:65], v[60:61], v[52:53] op_sel:[0,0] op_sel_hi:[0,1]
    v_pk_fma_f32 v[60:61], v[60:61], v[52:53], v[64:65] op_sel:[1,1,0] op_sel_hi:[1,0,1] neg_lo:[1,0,0]
    v_cvt_pk_bf16_f32 v70, v60, v61
    ds_write_addtid_b32 v70 offset:4320
    ds_read_b128 v[72:75], v34 offset:0
    ds_read_b128 v[76:79], v34 offset:64
    ds_read_b128 v[80:83], v34 offset:128
    ds_read_b128 v[84:87], v34 offset:192
    v_mul_f32 v36, 0x43000000, v48
    v_mul_f32 v37, 0x43000000, v49
    v_fract_f32 v37, v37
    v_exp_f32 v36, v36
    v_cos_f32 v60, v37
    v_sin_f32 v61, v37
    s_nop 0
    v_pk_mul_f32 v[60:61], v[60:61], v[36:37] op_sel_hi:[1,0]
    v_cvt_pk_bf16_f32 v71, v60, v61
    ds_write_addtid_b32 v71 offset:0
    v_pk_mul_f32 v[64:65], v[60:61], v[52:53] op_sel:[0,0] op_sel_hi:[0,1]
    v_pk_fma_f32 v[60:61], v[60:61], v[52:53], v[64:65] op_sel:[1,1,0] op_sel_hi:[1,0,1] neg_lo:[1,0,0]
    v_cvt_pk_bf16_f32 v68, v60, v61
    ds_write_addtid_b32 v68 offset:288
    v_pk_mul_f32 v[64:65], v[60:61], v[52:53] op_sel:[0,0] op_sel_hi:[0,1]
    v_pk_fma_f32 v[60:61], v[60:61], v[52:53], v[64:65] op_sel:[1,1,0] op_sel_hi:[1,0,1] neg_lo:[1,0,0]
    v_cvt_pk_bf16_f32 v69, v60, v61
    ds_write_addtid_b32 v69 offset:576
    v_pk_mul_f32 v[64:65], v[60:61], v[52:53] op_sel:[0,0] op_sel_hi:[0,1]
    v_pk_fma_f32 v[60:61], v[60:61], v[52:53], v[64:65] op_sel:[1,1,0] op_sel_hi:[1,0,1] neg_lo:[1,0,0]
    v_cvt_pk_bf16_f32 v70, v60, v61
    ds_write_addtid_b32 v70 offset:864
    v_pk_mul_f32 v[64:65], v[60:61], v[52:53] op_sel:[0,0] op_sel_hi:[0,1]
    v_pk_fma_f32 v[60:61], v[60:61], v[52:53], v[64:65] op_sel:[1,1,0] op_sel_hi:[1,0,1] neg_lo:[1,0,0]
    v_cvt_pk_bf16_f32 v71, v60, v61
    ds_write_addtid_b32 v71 offset:1152
    v_pk_mul_f32 v[64:65], v[60:61], v[52:53] op_sel:[0,0] op_sel_hi:[0,1]
    v_pk_fma_f32 v[60:61], v[60:61], v[52:53], v[64:65] op_sel:[1,1,0] op_sel_hi:[1,0,1] neg_lo:[1,0,0]
    v_cvt_pk_bf16_f32 v68, v60, v61
    ds_write_addtid_b32 v68 offset:1440
    v_pk_mul_f32 v[64:65], v[60:61], v[52:53] op_sel:[0,0] op_sel_hi:[0,1]
    v_pk_fma_f32 v[60:61], v[60:61], v[52:53], v[64:65] op_sel:[1,1,0] op_sel_hi:[1,0,1] neg_lo:[1,0,0]
    v_cvt_pk_bf16_f32 v69, v60, v61
    ds_write_addtid_b32 v69 offset:1728
    v_pk_mul_f32 v[64:65], v[60:61], v[52:53] op_sel:[0,0] op_sel_hi:[0,1]
    v_pk_fma_f32 v[60:61], v[60:61], v[52:53], v[64:65] op_sel:[1,1,0] op_sel_hi:[1,0,1] neg_lo:[1,0,0]
    v_cvt_pk_bf16_f32 v70, v60, v61
    ds_write_addtid_b32 v70 offset:2016
    v_pk_mul_f32 v[64:65], v[60:61], v[52:53] op_sel:[0,0] op_sel_hi:[0,1]
    v_pk_fma_f32 v[60:61], v[60:61], v[52:53], v[64:65] op_sel:[1,1,0] op_sel_hi:[1,0,1] neg_lo:[1,0,0]
    v_cvt_pk_bf16_f32 v71, v60, v61
    ds_write_addtid_b32 v71 offset:2304
    v_pk_mul_f32 v[64:65], v[60:61], v[52:53] op_sel:[0,0] op_sel_hi:[0,1]
    v_pk_fma_f32 v[60:61], v[60:61], v[52:53], v[64:65] op_sel:[1,1,0] op_sel_hi:[1,0,1] neg_lo:[1,0,0]
    v_cvt_pk_bf16_f32 v68, v60, v61
    ds_write_addtid_b32 v68 offset:2592
    v_pk_mul_f32 v[64:65], v[60:61], v[52:53] op_sel:[0,0] op_sel_hi:[0,1]
    v_pk_fma_f32 v[60:61], v[60:61], v[52:53], v[64:65] op_sel:[1,1,0] op_sel_hi:[1,0,1] neg_lo:[1,0,0]
    v_cvt_pk_bf16_f32 v69, v60, v61
    ds_write_addtid_b32 v69 offset:2880
    v_pk_mul_f32 v[64:65], v[60:61], v[52:53] op_sel:[0,0] op_sel_hi:[0,1]
    v_pk_fma_f32 v[60:61], v[60:61], v[52:53], v[64:65] op_sel:[1,1,0] op_sel_hi:[1,0,1] neg_lo:[1,0,0]
    v_cvt_pk_bf16_f32 v70, v60, v61
    ds_write_addtid_b32 v70 offset:3168
    v_pk_mul_f32 v[64:65], v[60:61], v[52:53] op_sel:[0,0] op_sel_hi:[0,1]
    v_pk_fma_f32 v[60:61], v[60:61], v[52:53], v[64:65] op_sel:[1,1,0] op_sel_hi:[1,0,1] neg_lo:[1,0,0]
    v_cvt_pk_bf16_f32 v71, v60, v61
    ds_write_addtid_b32 v71 offset:3456
    v_pk_mul_f32 v[64:65], v[60:61], v[52:53] op_sel:[0,0] op_sel_hi:[0,1]
    v_pk_fma_f32 v[60:61], v[60:61], v[52:53], v[64:65] op_sel:[1,1,0] op_sel_hi:[1,0,1] neg_lo:[1,0,0]
    v_cvt_pk_bf16_f32 v68, v60, v61
    ds_write_addtid_b32 v68 offset:3744
    v_pk_mul_f32 v[64:65], v[60:61], v[52:53] op_sel:[0,0] op_sel_hi:[0,1]
    v_pk_fma_f32 v[60:61], v[60:61], v[52:53], v[64:65] op_sel:[1,1,0] op_sel_hi:[1,0,1] neg_lo:[1,0,0]
    v_cvt_pk_bf16_f32 v69, v60, v61
    ds_write_addtid_b32 v69 offset:4032
    v_pk_mul_f32 v[64:65], v[60:61], v[52:53] op_sel:[0,0] op_sel_hi:[0,1]
    v_pk_fma_f32 v[60:61], v[60:61], v[52:53], v[64:65] op_sel:[1,1,0] op_sel_hi:[1,0,1] neg_lo:[1,0,0]
    v_cvt_pk_bf16_f32 v70, v60, v61
    ds_write_addtid_b32 v70 offset:4320
    ds_read_b128 v[88:91], v34 offset:0
    ds_read_b128 v[92:95], v34 offset:64
    ds_read_b128 v[96:99], v34 offset:128
    ds_read_b128 v[100:103], v34 offset:192
    v_mul_f32 v36, 0x43800000, v48
    v_mul_f32 v37, 0x43800000, v49
    v_fract_f32 v37, v37
    v_exp_f32 v36, v36
    v_cos_f32 v54, v37
    v_sin_f32 v55, v37
    s_nop 0
    s_setprio 0
    v_pk_mul_f32 v[54:55], v[54:55], v[36:37] op_sel_hi:[1,0]
    s_waitcnt vmcnt(4)
    v_lshlrev_b32 v42, 16, v42
    v_lshlrev_b32 v43, 16, v43
    v_lshlrev_b32 v44, 16, v44
    v_lshlrev_b32 v45, 16, v45
    v_pk_mul_f32 v[64:65], v[44:45], v[42:43] op_sel:[0,0] op_sel_hi:[0,1]
    v_pk_fma_f32 v[58:59], v[44:45], v[42:43], v[64:65] op_sel:[1,1,0] op_sel_hi:[1,0,1] neg_lo:[1,0,0]
    v_mul_f32 v58, v47, v58
    v_mul_f32 v59, v47, v59
    v_pk_mul_f32 v[64:65], v[58:59], v[54:55] op_sel:[0,0] op_sel_hi:[0,1]
    v_pk_fma_f32 v[136:137], v[58:59], v[54:55], v[64:65] op_sel:[1,1,0] op_sel_hi:[1,0,1] neg_lo:[1,0,0]
    v_pk_mul_f32 v[64:65], v[136:137], v[54:55] op_sel:[0,0] op_sel_hi:[0,1]
    v_pk_fma_f32 v[138:139], v[136:137], v[54:55], v[64:65] op_sel:[1,1,0] op_sel_hi:[1,0,1] neg_lo:[1,0,0]
    v_pk_mul_f32 v[64:65], v[138:139], v[54:55] op_sel:[0,0] op_sel_hi:[0,1]
    v_pk_fma_f32 v[140:141], v[138:139], v[54:55], v[64:65] op_sel:[1,1,0] op_sel_hi:[1,0,1] neg_lo:[1,0,0]
    v_pk_mul_f32 v[64:65], v[140:141], v[54:55] op_sel:[0,0] op_sel_hi:[0,1]
    v_pk_fma_f32 v[60:61], v[140:141], v[54:55], v[64:65] op_sel:[1,1,0] op_sel_hi:[1,0,1] neg_lo:[1,0,0]
    v_cvt_pk_bf16_f32 v71, v60, -v61
    ds_write_addtid_b32 v71 offset:0
    v_pk_mul_f32 v[64:65], v[60:61], v[54:55] op_sel:[0,0] op_sel_hi:[0,1]
    v_pk_fma_f32 v[60:61], v[60:61], v[54:55], v[64:65] op_sel:[1,1,0] op_sel_hi:[1,0,1] neg_lo:[1,0,0]
    v_cvt_pk_bf16_f32 v68, v60, -v61
    ds_write_addtid_b32 v68 offset:288
    v_pk_mul_f32 v[64:65], v[60:61], v[54:55] op_sel:[0,0] op_sel_hi:[0,1]
    v_pk_fma_f32 v[60:61], v[60:61], v[54:55], v[64:65] op_sel:[1,1,0] op_sel_hi:[1,0,1] neg_lo:[1,0,0]
    v_cvt_pk_bf16_f32 v69, v60, -v61
    ds_write_addtid_b32 v69 offset:576
    v_pk_mul_f32 v[64:65], v[60:61], v[54:55] op_sel:[0,0] op_sel_hi:[0,1]
    v_pk_fma_f32 v[60:61], v[60:61], v[54:55], v[64:65] op_sel:[1,1,0] op_sel_hi:[1,0,1] neg_lo:[1,0,0]
    v_cvt_pk_bf16_f32 v70, v60, -v61
    ds_write_addtid_b32 v70 offset:864
    s_mov_b64 exec, 0xfffffff
    s_bitcmp1_b32 s69, 0
    s_cbranch_scc1 L_PFD
    v_mul_u32_u24 v249, 3584, v1
    s_mul_i32 s89, s73, 100352
    s_lshl_b32 s90, s74, 8
    s_add_u32 s89, s89, s90
    buffer_load_dword v253, v249, s[52:55], s89 offen offset:128
    s_branch L_PFE
L_PFD:
    s_lshr_b32 s89, s70, 1
    s_lshl1_add_u32 s89, s75, s89
    s_mul_i32 s89, s89, 14
    v_add_u32 v249, s89, v1
    v_and_b32 v250, 0xffc0, v249
    v_add_u32 v249, v249, v250
    v_mul_u32_u24 v249, 896, v249
    s_lshl_b32 s89, s76, 7
    s_mov_b64 exec, 0x3fff
    buffer_load_dword v253, v249, s[56:59], s89 offen
L_PFE:
    s_mov_b64 exec, -1
    v_pk_mul_f32 v[64:65], v[60:61], v[54:55] op_sel:[0,0] op_sel_hi:[0,1]
    v_pk_fma_f32 v[60:61], v[60:61], v[54:55], v[64:65] op_sel:[1,1,0] op_sel_hi:[1,0,1] neg_lo:[1,0,0]
    v_cvt_pk_bf16_f32 v71, v60, -v61
    ds_write_addtid_b32 v71 offset:1152
    ds_read_b128 v[120:123], v34 offset:0
    ds_read_b128 v[124:127], v34 offset:64
    ds_read_b128 v[128:131], v34 offset:128
    ds_read_b128 v[132:135], v34 offset:192
    v_fract_f32 v37, v49
    v_exp_f32 v36, v48
    v_cos_f32 v50, v37
    v_sin_f32 v51, v37
    s_nop 0
    v_pk_mul_f32 v[50:51], v[50:51], v[36:37] op_sel_hi:[1,0]
    v_cvt_pk_bf16_f32 v68, v58, -v59
    ds_write_addtid_b32 v68 offset:0
    v_cvt_pk_bf16_f32 v69, v136, -v137
    ds_write_addtid_b32 v69 offset:2304
    v_cvt_pk_bf16_f32 v70, v138, -v139
    ds_write_addtid_b32 v70 offset:3456
    v_cvt_pk_bf16_f32 v71, v140, -v141
    ds_write_addtid_b32 v71 offset:4032
    s_waitcnt lgkmcnt(4)
    v_pk_mul_f32 v[64:65], v[58:59], v[50:51] op_sel:[0,0] op_sel_hi:[0,1]
    v_pk_fma_f32 v[60:61], v[58:59], v[50:51], v[64:65] op_sel:[1,1,0] op_sel_hi:[1,0,1] neg_lo:[1,0,0]
    v_cvt_pk_bf16_f32 v68, v60, -v61
    ds_write_addtid_b32 v68 offset:288
    v_mfma_f32_16x16x32_bf16 v[156:159], v[120:123], v[72:75], 0
    v_pk_mul_f32 v[64:65], v[60:61], v[50:51] op_sel:[0,0] op_sel_hi:[0,1]
    v_pk_fma_f32 v[60:61], v[60:61], v[50:51], v[64:65] op_sel:[1,1,0] op_sel_hi:[1,0,1] neg_lo:[1,0,0]
    v_cvt_pk_bf16_f32 v69, v60, -v61
    ds_write_addtid_b32 v69 offset:576
    v_mfma_f32_16x16x32_bf16 v[160:163], v[120:123], v[88:91], 0
    v_pk_mul_f32 v[64:65], v[60:61], v[54:55] op_sel:[0,0] op_sel_hi:[0,1]
    v_pk_fma_f32 v[136:137], v[60:61], v[54:55], v[64:65] op_sel:[1,1,0] op_sel_hi:[1,0,1] neg_lo:[1,0,0]
    v_cvt_pk_bf16_f32 v70, v136, -v137
    ds_write_addtid_b32 v70 offset:2592
    v_pk_mul_f32 v[64:65], v[60:61], v[50:51] op_sel:[0,0] op_sel_hi:[0,1]
    v_pk_fma_f32 v[60:61], v[60:61], v[50:51], v[64:65] op_sel:[1,1,0] op_sel_hi:[1,0,1] neg_lo:[1,0,0]
    v_cvt_pk_bf16_f32 v71, v60, -v61
    ds_write_addtid_b32 v71 offset:864
    v_mfma_f32_16x16x32_bf16 v[156:159], v[124:127], v[76:79], v[156:159]
    v_pk_mul_f32 v[64:65], v[60:61], v[50:51] op_sel:[0,0] op_sel_hi:[0,1]
    v_pk_fma_f32 v[60:61], v[60:61], v[50:51], v[64:65] op_sel:[1,1,0] op_sel_hi:[1,0,1] neg_lo:[1,0,0]
    v_cvt_pk_bf16_f32 v68, v60, -v61
    ds_write_addtid_b32 v68 offset:1152
    v_mfma_f32_16x16x32_bf16 v[160:163], v[124:127], v[92:95], v[160:163]
    v_pk_mul_f32 v[64:65], v[60:61], v[54:55] op_sel:[0,0] op_sel_hi:[0,1]
    v_pk_fma_f32 v[136:137], v[60:61], v[54:55], v[64:65] op_sel:[1,1,0] op_sel_hi:[1,0,1] neg_lo:[1,0,0]
    v_cvt_pk_bf16_f32 v69, v136, -v137
    ds_write_addtid_b32 v69 offset:2880
    v_pk_mul_f32 v[64:65], v[136:137], v[54:55] op_sel:[0,0] op_sel_hi:[0,1]
    v_pk_fma_f32 v[136:137], v[136:137], v[54:55], v[64:65] op_sel:[1,1,0] op_sel_hi:[1,0,1] neg_lo:[1,0,0]
    v_cvt_pk_bf16_f32 v70, v136, -v137
    ds_write_addtid_b32 v70 offset:3744
    v_mfma_f32_16x16x32_bf16 v[156:159], v[128:131], v[80:83], v[156:159]
    v_pk_mul_f32 v[64:65], v[136:137], v[54:55] op_sel:[0,0] op_sel_hi:[0,1]
    v_pk_fma_f32 v[136:137], v[136:137], v[54:55], v[64:65] op_sel:[1,1,0] op_sel_hi:[1,0,1] neg_lo:[1,0,0]
    v_cvt_pk_bf16_f32 v71, v136, -v137
    ds_write_addtid_b32 v71 offset:4320
    v_pk_mul_f32 v[64:65], v[60:61], v[50:51] op_sel:[0,0] op_sel_hi:[0,1]
    v_pk_fma_f32 v[60:61], v[60:61], v[50:51], v[64:65] op_sel:[1,1,0] op_sel_hi:[1,0,1] neg_lo:[1,0,0]
    v_cvt_pk_bf16_f32 v68, v60, -v61
    ds_write_addtid_b32 v68 offset:1440
    v_mfma_f32_16x16x32_bf16 v[160:163], v[128:131], v[96:99], v[160:163]
    v_pk_mul_f32 v[64:65], v[60:61], v[50:51] op_sel:[0,0] op_sel_hi:[0,1]
    v_pk_fma_f32 v[60:61], v[60:61], v[50:51], v[64:65] op_sel:[1,1,0] op_sel_hi:[1,0,1] neg_lo:[1,0,0]
    v_cvt_pk_bf16_f32 v69, v60, -v61
    ds_write_addtid_b32 v69 offset:1728
    v_mfma_f32_16x16x32_bf16 v[156:159], v[132:135], v[84:87], v[156:159]
    v_pk_mul_f32 v[64:65], v[60:61], v[54:55] op_sel:[0,0] op_sel_hi:[0,1]
    v_pk_fma_f32 v[136:137], v[60:61], v[54:55], v[64:65] op_sel:[1,1,0] op_sel_hi:[1,0,1] neg_lo:[1,0,0]
    v_cvt_pk_bf16_f32 v70, v136, -v137
    ds_write_addtid_b32 v70 offset:3168
    v_pk_mul_f32 v[64:65], v[60:61], v[50:51] op_sel:[0,0] op_sel_hi:[0,1]
    v_pk_fma_f32 v[60:61], v[60:61], v[50:51], v[64:65] op_sel:[1,1,0] op_sel_hi:[1,0,1] neg_lo:[1,0,0]
    v_cvt_pk_bf16_f32 v71, v60, -v61
    ds_write_addtid_b32 v71 offset:2016
    v_mfma_f32_16x16x32_bf16 v[160:163], v[132:135], v[100:103], v[160:163]
    ds_read_b128 v[104:107], v34 offset:0
    ds_read_b128 v[108:111], v34 offset:64
    ds_read_b128 v[112:115], v34 offset:128
    ds_read_b128 v[116:119], v34 offset:192
    v_lshl_add_u32 v36, v1, 4, s79
    ds_write_b128 v36, v[156:159] offset:2048
    s_add_u32 m0, s8, 98304
    s_mul_i32 s87, s81, 229376
    buffer_load_dwordx4 v6, s[52:55], s87 offen offset:0 lds
    s_mov_b32 m0, s79
    ds_write_b128 v36, v[160:163] offset:3072
    s_waitcnt lgkmcnt(2)
    s_add_u32 m0, s8, 98304
    s_nop 0
    buffer_load_dwordx4 v7, s[52:55], s87 offen offset:1024 lds
    s_mov_b32 m0, s79
    v_mfma_f32_16x16x32_bf16 v[148:151], v[104:107], v[72:75], 0
    v_mfma_f32_16x16x32_bf16 v[152:155], v[104:107], v[88:91], 0
    v_mfma_f32_16x16x32_bf16 v[148:151], v[108:111], v[76:79], v[148:151]
    s_add_u32 m0, s8, 98304
    s_nop 0
    buffer_load_dwordx4 v8, s[52:55], s87 offen offset:2048 lds
    s_mov_b32 m0, s79
    v_mfma_f32_16x16x32_bf16 v[152:155], v[108:111], v[92:95], v[152:155]
    v_mfma_f32_16x16x32_bf16 v[148:151], v[112:115], v[80:83], v[148:151]
    v_mfma_f32_16x16x32_bf16 v[152:155], v[112:115], v[96:99], v[152:155]
    s_add_u32 m0, s8, 98304
    s_nop 0
    buffer_load_dwordx4 v9, s[52:55], s87 offen offset:3072 lds
    s_mov_b32 m0, s79
    v_mfma_f32_16x16x32_bf16 v[148:151], v[116:119], v[84:87], v[148:151]
    v_mfma_f32_16x16x32_bf16 v[152:155], v[116:119], v[100:103], v[152:155]
    s_nop 6
    ds_write_b128 v36, v[148:151] offset:0
    ds_write_b128 v36, v[152:155] offset:1024
    v_lshrrev_b32 v249, 5, v1
    v_bfe_u32 v250, v1, 1, 3
    v_xor_b32 v249, v249, v250
    s_and_b32 s89, s8, 12288
    s_add_u32 s89, s89, 49152
    v_lshl_add_u32 v249, v249, 4, s89
    v_and_b32 v250, 31, v1
    v_lshl_add_u32 v18, v250, 7, v249
    v_xor_b32 v19, 32, v18
    v_xor_b32 v20, 64, v18
    v_xor_b32 v21, 96, v18
    v_add_u32 v22, 65536, v18
    v_add_u32 v23, 65536, v19
    v_add_u32 v24, 65536, v20
    v_add_u32 v25, 65536, v21
    s_waitcnt lgkmcnt(0)
    s_waitcnt vmcnt(5)
    s_barrier
    s_setprio 0
    s_add_u32 m0, s8, 114688
    s_lshl_b32 s87, s82, 7
    buffer_load_dwordx4 v2, s[48:51], s87 offen offset:0 lds
    buffer_load_dwordx4 v3, s[48:51], s87 offen offset:1024 lds
    buffer_load_dwordx4 v4, s[48:51], s87 offen offset:2048 lds
    buffer_load_dwordx4 v5, s[48:51], s87 offen offset:3072 lds
    s_add_u32 m0, s8, 131072
    s_mul_i32 s87, s82, 229376
    buffer_load_dwordx4 v6, s[52:55], s87 offen offset:0 lds
    buffer_load_dwordx4 v7, s[52:55], s87 offen offset:1024 lds
    buffer_load_dwordx4 v8, s[52:55], s87 offen offset:2048 lds
    buffer_load_dwordx4 v9, s[52:55], s87 offen offset:3072 lds
    s_add_u32 m0, s8, 147456
    s_lshl_b32 s87, s83, 7
    buffer_load_dwordx4 v2, s[48:51], s87 offen offset:0 lds
    ds_read_b128 v[128:131], v18 offset:0
    ds_read_b128 v[132:135], v19 offset:0
    ds_read_b128 v[136:139], v20 offset:0
    ds_read_b128 v[140:143], v21 offset:0
    s_waitcnt vmcnt(9)
    s_waitcnt lgkmcnt(0)
    s_barrier
    buffer_load_dwordx4 v3, s[48:51], s87 offen offset:1024 lds
    buffer_load_dwordx4 v4, s[48:51], s87 offen offset:2048 lds
    buffer_load_dwordx4 v5, s[48:51], s87 offen offset:3072 lds
    s_add_u32 m0, s8, 49152
    s_mul_i32 s87, s83, 229376
    buffer_load_dwordx4 v6, s[52:55], s87 offen offset:0 lds
    buffer_load_dwordx4 v7, s[52:55], s87 offen offset:1024 lds
    buffer_load_dwordx4 v8, s[52:55], s87 offen offset:2048 lds
    buffer_load_dwordx4 v9, s[52:55], s87 offen offset:3072 lds
    s_add_u32 m0, s8, 65536
    s_lshl_b32 s87, s84, 7
    buffer_load_dwordx4 v2, s[48:51], s87 offen offset:0 lds
    buffer_load_dwordx4 v3, s[48:51], s87 offen offset:1024 lds
    ds_read_b128 v[144:147], v18 offset:32768
    ds_read_b128 v[148:151], v19 offset:32768
    ds_read_b128 v[152:155], v20 offset:32768
    ds_read_b128 v[156:159], v21 offset:32768
    s_waitcnt vmcnt(10)
    s_waitcnt lgkmcnt(0)
    s_barrier
    buffer_load_dwordx4 v4, s[48:51], s87 offen offset:2048 lds
    v_bfe_u32 v249, v1, 4, 1
    v_mul_u32_u24 v10, 8256, v249
    v_lshrrev_b32 v249, 5, v1
    buffer_load_dwordx4 v5, s[48:51], s87 offen offset:3072 lds
    v_lshl_add_u32 v10, v249, 10, v10
    v_bfe_u32 v249, v1, 2, 2
    s_add_u32 m0, s8, 81920
    s_mul_i32 s87, s84, 229376
    buffer_load_dwordx4 v6, s[52:55], s87 offen offset:0 lds
    v_lshl_add_u32 v10, v249, 7, v10
    v_bfe_u32 v249, v1, 3, 1
    buffer_load_dwordx4 v7, s[52:55], s87 offen offset:1024 lds
    v_lshl_add_u32 v10, v249, 5, v10
    v_and_b32 v249, 1, v1
    buffer_load_dwordx4 v8, s[52:55], s87 offen offset:2048 lds
    v_lshl_add_u32 v10, v249, 4, v10
    v_bfe_u32 v249, v1, 1, 1
    v_lshl_add_u32 v10, v249, 3, v10
    buffer_load_dwordx4 v9, s[52:55], s87 offen offset:3072 lds
    v_add_u32 v10, 49152, v10
    v_xor_b32 v11, 32, v10
    s_add_u32 m0, s8, 98304
    s_lshl_b32 s87, s85, 7
    buffer_load_dwordx4 v2, s[48:51], s87 offen offset:0 lds
    v_xor_b32 v12, 64, v10
    v_xor_b32 v13, 96, v10
    buffer_load_dwordx4 v3, s[48:51], s87 offen offset:1024 lds
    v_add_u32 v14, 65536, v10
    v_add_u32 v15, 65536, v11
    buffer_load_dwordx4 v4, s[48:51], s87 offen offset:2048 lds
    v_add_u32 v16, 65536, v12
    v_add_u32 v17, 65536, v13
    ds_read_b128 v[160:163], v22 offset:0
    ds_read_b128 v[164:167], v23 offset:0
    ds_read_b128 v[168:171], v24 offset:0
    ds_read_b128 v[172:175], v25 offset:0
    s_waitcnt vmcnt(11)
    s_waitcnt lgkmcnt(0)
    s_barrier
    buffer_load_dwordx4 v5, s[48:51], s87 offen offset:3072 lds
    v_bfe_u32 v249, v1, 3, 2
    v_bfe_u32 v250, v1, 2, 1
    v_lshl_add_u32 v249, v249, 5, v250
    s_add_u32 m0, s8, 114688
    s_mul_i32 s87, s85, 229376
    buffer_load_dwordx4 v6, s[52:55], s87 offen offset:0 lds
    v_and_b32 v250, 3, v1
    v_lshl_add_u32 v249, v250, 1, v249
    buffer_load_dwordx4 v7, s[52:55], s87 offen offset:1024 lds
    s_and_b32 s88, s77, 65535
    s_lshl_b32 s88, s88, 3
    s_add_u32 s88, s88, 32768
    buffer_load_dwordx4 v8, s[52:55], s87 offen offset:2048 lds
    v_lshl_add_u32 v246, v249, 3, s88
    v_bfe_u32 v249, v1, 4, 1
    buffer_load_dwordx4 v9, s[52:55], s87 offen offset:3072 lds
    v_mul_u32_u24 v249, 1792, v249
    v_add_u32 v249, v249, v250
    v_bfe_u32 v250, v1, 2, 1
    s_add_u32 m0, s8, 131072
    s_lshl_b32 s87, s86, 7
    buffer_load_dwordx4 v2, s[48:51], s87 offen offset:0 lds
    v_lshl_add_u32 v249, v250, 3, v249
    v_bfe_u32 v250, v1, 3, 1
    buffer_load_dwordx4 v3, s[48:51], s87 offen offset:1024 lds
    v_lshl_add_u32 v249, v250, 2, v249
    v_lshrrev_b32 v250, 5, v1
    buffer_load_dwordx4 v4, s[48:51], s87 offen offset:2048 lds
    v_lshl_add_u32 v249, v250, 4, v249
    s_lshl_b32 s88, s74, 10
    s_add_u32 s88, s88, 49664
    buffer_load_dwordx4 v5, s[48:51], s87 offen offset:3072 lds
    v_lshl_add_u32 v247, v249, 3, s88
    v_lshlrev_b32 v248, 4, v1
    ds_read_b128 v[176:179], v22 offset:32768
    ds_read_b128 v[180:183], v23 offset:32768
    ds_read_b128 v[184:187], v24 offset:32768
    ds_read_b128 v[188:191], v25 offset:32768
    s_waitcnt vmcnt(12)
    s_waitcnt lgkmcnt(0)
    s_barrier
    buffer_load_dwordx2 v[240:241], v246, s[60:63], 0 offen sc1
    s_add_u32 m0, s8, 147456
    s_mul_i32 s87, s86, 229376
    buffer_load_dwordx4 v6, s[52:55], s87 offen offset:0 lds
    v_bfe_u32 v249, v1, 2, 2
    v_lshrrev_b32 v250, 5, v1
    v_lshlrev_b32 v26, 10, v250
    v_lshl_add_u32 v26, v249, 7, v26
    buffer_load_dwordx4 v7, s[52:55], s87 offen offset:1024 lds
    v_lshrrev_b32 v249, 1, v249
    v_lshl_add_u32 v26, v249, 6, v26
    v_bfe_u32 v249, v1, 4, 1
    buffer_load_dwordx4 v8, s[52:55], s87 offen offset:2048 lds
    v_lshl_add_u32 v26, v249, 5, v26
    v_and_b32 v249, 3, v1
    v_lshl_add_u32 v26, v249, 3, v26
    buffer_load_dwordx4 v9, s[52:55], s87 offen offset:3072 lds
    s_lshr_b32 s88, s70, 1
    s_lshl_b32 s88, s88, 13
    v_add_u32 v26, s88, v26
    v_xor_b32 v27, 64, v26
    s_add_u32 m0, s8, 49152
    s_mul_i32 s87, s80, 229376
    s_add_u32 s87, s87, 128
    buffer_load_dwordx4 v6, s[52:55], s87 offen offset:0 lds
    v_add_u32 v28, 49152, v26
    v_add_u32 v29, 49152, v27
    v_add_u32 v30, 114688, v26
    buffer_load_dwordx4 v7, s[52:55], s87 offen offset:1024 lds
    v_add_u32 v31, 114688, v27
    s_lshl_b32 s88, s73, 2
    s_add_u32 s88, s88, s70
    s_mul_i32 s95, s88, 114688
    buffer_load_dwordx4 v8, s[52:55], s87 offen offset:2048 lds
    s_lshl_b32 s89, s74, 13
    s_add_u32 s95, s95, s89
    s_add_u32 s95, s95, 4198400
    s_lshl_b32 s96, s88, 8
    buffer_load_dwordx4 v9, s[52:55], s87 offen offset:3072 lds
    s_lshl_b32 s89, s74, 2
    s_add_u32 s96, s96, s89
    s_lshl_b32 s96, s96, 3
    s_add_u32 s96, s96, 3933184
    ds_read_b128 v[192:195], v18 offset:16384
    ds_read_b128 v[196:199], v19 offset:16384
    ds_read_b128 v[200:203], v20 offset:16384
    ds_read_b128 v[204:207], v21 offset:16384
    s_waitcnt vmcnt(13)
    s_waitcnt lgkmcnt(0)
    s_barrier
    s_add_u32 m0, s8, 65536
    s_mul_i32 s87, s81, 229376
    s_add_u32 s87, s87, 128
    buffer_load_dwordx4 v6, s[52:55], s87 offen offset:0 lds
    s_lshl_b32 s88, s75, 1
    s_and_b32 s89, s70, 1
    s_add_u32 s88, s88, s89
    buffer_load_dwordx4 v7, s[52:55], s87 offen offset:1024 lds
    s_mul_i32 s97, s88, 114688
    s_lshr_b32 s89, s70, 1
    s_lshl_b32 s89, s89, 13
    buffer_load_dwordx4 v8, s[52:55], s87 offen offset:2048 lds
    s_add_u32 s97, s97, s89
    s_add_u32 s97, s97, 4194304
    buffer_load_dwordx4 v9, s[52:55], s87 offen offset:3072 lds
    s_lshl_b32 s88, s88, 11
    s_add_u32 s88, s88, 3932160
    v_min_u32 v252, 27, v1
    s_add_u32 m0, s8, 81920
    s_mul_i32 s87, s82, 229376
    s_add_u32 s87, s87, 128
    buffer_load_dwordx4 v6, s[52:55], s87 offen offset:0 lds
    v_lshl_add_u32 v252, v252, 5, s88
    v_and_b32 v249, 31, v1
    buffer_load_dwordx4 v7, s[52:55], s87 offen offset:1024 lds
    v_mul_u32_u24 v4, 272, v249
    v_lshrrev_b32 v249, 5, v1
    buffer_load_dwordx4 v8, s[52:55], s87 offen offset:2048 lds
    v_lshl_add_u32 v4, v249, 4, v4
    s_mul_i32 s88, s70, 8704
    buffer_load_dwordx4 v9, s[52:55], s87 offen offset:3072 lds
    s_add_u32 s88, s88, 0
    v_add_u32 v4, s88, v4
    ds_read_b128 v[208:211], v18 offset:49152
    ds_read_b128 v[212:215], v19 offset:49152
    ds_read_b128 v[216:219], v20 offset:49152
    ds_read_b128 v[220:223], v21 offset:49152
    s_waitcnt vmcnt(12)
    s_waitcnt lgkmcnt(0)
    s_barrier
    s_mov_b32 s94, 0
PAG_4:
    v_cmp_ne_u32 vcc, s68, v241
    s_cbranch_vccz POK_3
    s_add_u32 s94, s94, 1
    s_cmp_gt_u32 s94, 0x40000
    s_cbranch_scc1 POK_3
    s_sleep 2
    buffer_load_dwordx2 v[240:241], v246, s[60:63], 0 offen sc1
    s_waitcnt vmcnt(0)
    s_branch PAG_4
POK_3:
    s_add_u32 m0, s8, 98304
    s_mul_i32 s87, s83, 229376
    s_add_u32 s87, s87, 128
    buffer_load_dwordx4 v6, s[52:55], s87 offen offset:0 lds
    v_and_b32 v244, 0xffff0000, v240
    buffer_load_dwordx4 v7, s[52:55], s87 offen offset:1024 lds
    v_rcp_f32 v245, v244
    buffer_load_dwordx4 v8, s[52:55], s87 offen offset:2048 lds
    buffer_load_dwordx4 v9, s[52:55], s87 offen offset:3072 lds
    v_and_b32 v3, 0xffff, v240
    s_add_u32 m0, s8, 114688
    s_mul_i32 s87, s84, 229376
    s_add_u32 s87, s87, 128
    buffer_load_dwordx4 v6, s[52:55], s87 offen offset:0 lds
    v_xor_b32 v3, 0x8000, v3
    buffer_load_dwordx4 v7, s[52:55], s87 offen offset:1024 lds
    v_lshl_or_b32 v2, v3, 16, v3
    buffer_load_dwordx4 v8, s[52:55], s87 offen offset:2048 lds
    v_mul_f32 v245, 0xbfb8aa3b, v245
    buffer_load_dwordx4 v9, s[52:55], s87 offen offset:3072 lds
    ds_read_b128 v[224:227], v22 offset:16384
    ds_read_b128 v[228:231], v23 offset:16384
    ds_read_b128 v[232:235], v24 offset:16384
    ds_read_b128 v[236:239], v25 offset:16384
    s_waitcnt vmcnt(8)
    s_waitcnt lgkmcnt(0)
    s_barrier
    s_setprio 1
    ds_read_b64_tr_b16 v[32:33], v10 offset:0
    ds_read_b64_tr_b16 v[34:35], v10 offset:512
    ds_read_b64_tr_b16 v[36:37], v11 offset:0
    ds_read_b64_tr_b16 v[38:39], v11 offset:512
    ds_read_b64_tr_b16 v[40:41], v12 offset:0
    ds_read_b64_tr_b16 v[42:43], v12 offset:512
    ds_read_b64_tr_b16 v[44:45], v13 offset:0
    ds_read_b64_tr_b16 v[46:47], v13 offset:512
    s_waitcnt lgkmcnt(6)
    v_mfma_f32_32x32x16_bf16 v[64:79], v[32:35], v[128:131], 0
    ds_read_b64_tr_b16 v[48:49], v10 offset:2048
    ds_read_b64_tr_b16 v[50:51], v10 offset:2560
    ds_read_b64_tr_b16 v[52:53], v11 offset:2048
    ds_read_b64_tr_b16 v[54:55], v11 offset:2560
    s_waitcnt lgkmcnt(8)
    v_mfma_f32_32x32x16_bf16 v[80:95], v[36:39], v[128:131], 0
    s_add_u32 m0, s8, 131072
    s_mul_i32 s87, s85, 229376
    s_add_u32 s87, s87, 128
    buffer_load_dwordx4 v6, s[52:55], s87 offen offset:0 lds
    s_waitcnt lgkmcnt(6)
    v_mfma_f32_32x32x16_bf16 v[96:111], v[40:43], v[128:131], 0
    ds_read_b64_tr_b16 v[56:57], v12 offset:2048
    ds_read_b64_tr_b16 v[58:59], v12 offset:2560
    ds_read_b64_tr_b16 v[60:61], v13 offset:2048
    ds_read_b64_tr_b16 v[62:63], v13 offset:2560
    s_waitcnt lgkmcnt(8)
    v_mfma_f32_32x32x16_bf16 v[112:127], v[44:47], v[128:131], 0
    buffer_load_dwordx4 v7, s[52:55], s87 offen offset:1024 lds
    s_waitcnt lgkmcnt(6)
    v_mfma_f32_32x32x16_bf16 v[64:79], v[48:51], v[132:135], v[64:79]
    ds_read_b64_tr_b16 v[32:33], v10 offset:4096
    ds_read_b64_tr_b16 v[34:35], v10 offset:4608
    ds_read_b64_tr_b16 v[36:37], v11 offset:4096
    ds_read_b64_tr_b16 v[38:39], v11 offset:4608
    s_waitcnt lgkmcnt(8)
    v_mfma_f32_32x32x16_bf16 v[80:95], v[52:55], v[132:135], v[80:95]
    buffer_load_dwordx4 v8, s[52:55], s87 offen offset:2048 lds
    s_waitcnt lgkmcnt(6)
    v_mfma_f32_32x32x16_bf16 v[96:111], v[56:59], v[132:135], v[96:111]
    ds_read_b64_tr_b16 v[40:41], v12 offset:4096
    ds_read_b64_tr_b16 v[42:43], v12 offset:4608
    ds_read_b64_tr_b16 v[44:45], v13 offset:4096
    ds_read_b64_tr_b16 v[46:47], v13 offset:4608
    s_waitcnt lgkmcnt(8)
    v_mfma_f32_32x32x16_bf16 v[112:127], v[60:63], v[132:135], v[112:127]
    buffer_load_dwordx4 v9, s[52:55], s87 offen offset:3072 lds
    s_waitcnt lgkmcnt(6)
    v_mfma_f32_32x32x16_bf16 v[64:79], v[32:35], v[136:139], v[64:79]
    ds_read_b64_tr_b16 v[48:49], v10 offset:6144
    ds_read_b64_tr_b16 v[50:51], v10 offset:6656
    ds_read_b64_tr_b16 v[52:53], v11 offset:6144
    ds_read_b64_tr_b16 v[54:55], v11 offset:6656
    s_waitcnt lgkmcnt(8)
    v_mfma_f32_32x32x16_bf16 v[80:95], v[36:39], v[136:139], v[80:95]
    s_add_u32 m0, s8, 147456
    s_mul_i32 s87, s86, 229376
    s_add_u32 s87, s87, 128
    buffer_load_dwordx4 v6, s[52:55], s87 offen offset:0 lds
    s_waitcnt lgkmcnt(6)
    v_mfma_f32_32x32x16_bf16 v[96:111], v[40:43], v[136:139], v[96:111]
    ds_read_b64_tr_b16 v[56:57], v12 offset:6144
    ds_read_b64_tr_b16 v[58:59], v12 offset:6656
    ds_read_b64_tr_b16 v[60:61], v13 offset:6144
    ds_read_b64_tr_b16 v[62:63], v13 offset:6656
    s_waitcnt lgkmcnt(8)
    v_mfma_f32_32x32x16_bf16 v[112:127], v[44:47], v[136:139], v[112:127]
    buffer_load_dwordx4 v7, s[52:55], s87 offen offset:1024 lds
    s_waitcnt lgkmcnt(6)
    v_mfma_f32_32x32x16_bf16 v[64:79], v[48:51], v[140:143], v[64:79]
    ds_read_b64_tr_b16 v[32:33], v10 offset:16384
    ds_read_b64_tr_b16 v[34:35], v10 offset:16896
    ds_read_b64_tr_b16 v[36:37], v11 offset:16384
    ds_read_b64_tr_b16 v[38:39], v11 offset:16896
    s_waitcnt lgkmcnt(8)
    v_mfma_f32_32x32x16_bf16 v[80:95], v[52:55], v[140:143], v[80:95]
    buffer_load_dwordx4 v8, s[52:55], s87 offen offset:2048 lds
    s_waitcnt lgkmcnt(6)
    v_mfma_f32_32x32x16_bf16 v[96:111], v[56:59], v[140:143], v[96:111]
    ds_read_b64_tr_b16 v[40:41], v12 offset:16384
    ds_read_b64_tr_b16 v[42:43], v12 offset:16896
    ds_read_b64_tr_b16 v[44:45], v13 offset:16384
    ds_read_b64_tr_b16 v[46:47], v13 offset:16896
    s_waitcnt lgkmcnt(8)
    v_mfma_f32_32x32x16_bf16 v[112:127], v[60:63], v[140:143], v[112:127]
    buffer_load_dwordx4 v9, s[52:55], s87 offen offset:3072 lds
    s_waitcnt lgkmcnt(6)
    v_mfma_f32_32x32x16_bf16 v[64:79], v[32:35], v[144:147], v[64:79]
    ds_read_b64_tr_b16 v[48:49], v10 offset:18432
    ds_read_b64_tr_b16 v[50:51], v10 offset:18944
    ds_read_b64_tr_b16 v[52:53], v11 offset:18432
    ds_read_b64_tr_b16 v[54:55], v11 offset:18944
    s_waitcnt lgkmcnt(8)
    v_mfma_f32_32x32x16_bf16 v[80:95], v[36:39], v[144:147], v[80:95]
    ds_read_b64_tr_b16 v[56:57], v12 offset:18432
    ds_read_b64_tr_b16 v[58:59], v12 offset:18944
    ds_read_b64_tr_b16 v[60:61], v13 offset:18432
    ds_read_b64_tr_b16 v[62:63], v13 offset:18944
    s_waitcnt lgkmcnt(8)
    v_mfma_f32_32x32x16_bf16 v[96:111], v[40:43], v[144:147], v[96:111]
    ds_read_b64_tr_b16 v[32:33], v10 offset:20480
    ds_read_b64_tr_b16 v[34:35], v10 offset:20992
    ds_read_b64_tr_b16 v[36:37], v11 offset:20480
    ds_read_b64_tr_b16 v[38:39], v11 offset:20992
    v_mfma_f32_32x32x16_bf16 v[112:127], v[44:47], v[144:147], v[112:127]
    ds_read_b64_tr_b16 v[40:41], v12 offset:20480
    ds_read_b64_tr_b16 v[42:43], v12 offset:20992
    s_waitcnt lgkmcnt(10)
    v_mfma_f32_32x32x16_bf16 v[64:79], v[48:51], v[148:151], v[64:79]
    ds_read_b64_tr_b16 v[44:45], v13 offset:20480
    ds_read_b64_tr_b16 v[46:47], v13 offset:20992
    v_mfma_f32_32x32x16_bf16 v[80:95], v[52:55], v[148:151], v[80:95]
    ds_read_b64_tr_b16 v[48:49], v10 offset:22528
    ds_read_b64_tr_b16 v[50:51], v10 offset:23040
    s_waitcnt lgkmcnt(10)
    v_mfma_f32_32x32x16_bf16 v[96:111], v[56:59], v[148:151], v[96:111]
    ds_read_b64_tr_b16 v[52:53], v11 offset:22528
    ds_read_b64_tr_b16 v[54:55], v11 offset:23040
    v_mfma_f32_32x32x16_bf16 v[112:127], v[60:63], v[148:151], v[112:127]
    ds_read_b64_tr_b16 v[56:57], v12 offset:22528
    ds_read_b64_tr_b16 v[58:59], v12 offset:23040
    s_waitcnt lgkmcnt(10)
    v_mfma_f32_32x32x16_bf16 v[64:79], v[32:35], v[152:155], v[64:79]
    ds_read_b64_tr_b16 v[60:61], v13 offset:22528
    ds_read_b64_tr_b16 v[62:63], v13 offset:23040
    v_mfma_f32_32x32x16_bf16 v[80:95], v[36:39], v[152:155], v[80:95]
    ds_read_b64_tr_b16 v[32:33], v10 offset:32768
    ds_read_b64_tr_b16 v[34:35], v10 offset:33280
    s_waitcnt lgkmcnt(10)
    v_mfma_f32_32x32x16_bf16 v[96:111], v[40:43], v[152:155], v[96:111]
    ds_read_b64_tr_b16 v[36:37], v11 offset:32768
    ds_read_b64_tr_b16 v[38:39], v11 offset:33280
    v_mfma_f32_32x32x16_bf16 v[112:127], v[44:47], v[152:155], v[112:127]
    ds_read_b64_tr_b16 v[40:41], v12 offset:32768
    ds_read_b64_tr_b16 v[42:43], v12 offset:33280
    s_waitcnt lgkmcnt(10)
    v_mfma_f32_32x32x16_bf16 v[64:79], v[48:51], v[156:159], v[64:79]
    ds_read_b64_tr_b16 v[44:45], v13 offset:32768
    ds_read_b64_tr_b16 v[46:47], v13 offset:33280
    v_mfma_f32_32x32x16_bf16 v[80:95], v[52:55], v[156:159], v[80:95]
    ds_read_b64_tr_b16 v[48:49], v10 offset:34816
    ds_read_b64_tr_b16 v[50:51], v10 offset:35328
    s_waitcnt lgkmcnt(10)
    v_mfma_f32_32x32x16_bf16 v[96:111], v[56:59], v[156:159], v[96:111]
    ds_read_b64_tr_b16 v[52:53], v11 offset:34816
    ds_read_b64_tr_b16 v[54:55], v11 offset:35328
    v_mfma_f32_32x32x16_bf16 v[112:127], v[60:63], v[156:159], v[112:127]
    ds_read_b64_tr_b16 v[56:57], v12 offset:34816
    ds_read_b64_tr_b16 v[58:59], v12 offset:35328
    s_waitcnt lgkmcnt(10)
    v_mfma_f32_32x32x16_bf16 v[64:79], v[32:35], v[160:163], v[64:79]
    ds_read_b64_tr_b16 v[60:61], v13 offset:34816
    ds_read_b64_tr_b16 v[62:63], v13 offset:35328
    v_mfma_f32_32x32x16_bf16 v[80:95], v[36:39], v[160:163], v[80:95]
    ds_read_b64_tr_b16 v[32:33], v10 offset:36864
    ds_read_b64_tr_b16 v[34:35], v10 offset:37376
    s_waitcnt lgkmcnt(10)
    v_mfma_f32_32x32x16_bf16 v[96:111], v[40:43], v[160:163], v[96:111]
    ds_read_b64_tr_b16 v[36:37], v11 offset:36864
    ds_read_b64_tr_b16 v[38:39], v11 offset:37376
    v_mfma_f32_32x32x16_bf16 v[112:127], v[44:47], v[160:163], v[112:127]
    ds_read_b64_tr_b16 v[40:41], v12 offset:36864
    ds_read_b64_tr_b16 v[42:43], v12 offset:37376
    s_waitcnt lgkmcnt(10)
    v_mfma_f32_32x32x16_bf16 v[64:79], v[48:51], v[164:167], v[64:79]
    ds_read_b64_tr_b16 v[44:45], v13 offset:36864
    ds_read_b64_tr_b16 v[46:47], v13 offset:37376
    v_mfma_f32_32x32x16_bf16 v[80:95], v[52:55], v[164:167], v[80:95]
    ds_read_b64_tr_b16 v[48:49], v10 offset:38912
    ds_read_b64_tr_b16 v[50:51], v10 offset:39424
    s_waitcnt lgkmcnt(10)
    v_mfma_f32_32x32x16_bf16 v[96:111], v[56:59], v[164:167], v[96:111]
    ds_read_b64_tr_b16 v[52:53], v11 offset:38912
    ds_read_b64_tr_b16 v[54:55], v11 offset:39424
    v_mfma_f32_32x32x16_bf16 v[112:127], v[60:63], v[164:167], v[112:127]
    ds_read_b64_tr_b16 v[56:57], v12 offset:38912
    ds_read_b64_tr_b16 v[58:59], v12 offset:39424
    s_waitcnt lgkmcnt(10)
    v_mfma_f32_32x32x16_bf16 v[64:79], v[32:35], v[168:171], v[64:79]
    ds_read_b64_tr_b16 v[60:61], v13 offset:38912
    ds_read_b64_tr_b16 v[62:63], v13 offset:39424
    v_mfma_f32_32x32x16_bf16 v[80:95], v[36:39], v[168:171], v[80:95]
    s_waitcnt lgkmcnt(8)
    v_mfma_f32_32x32x16_bf16 v[96:111], v[40:43], v[168:171], v[96:111]
    v_mfma_f32_32x32x16_bf16 v[112:127], v[44:47], v[168:171], v[112:127]
    s_waitcnt vmcnt(0)
    s_waitcnt lgkmcnt(0)
    v_mfma_f32_32x32x16_bf16 v[64:79], v[48:51], v[172:175], v[64:79]
    s_barrier
    ds_read_b64_tr_b16 v[32:33], v10 offset:49152
    ds_read_b64_tr_b16 v[34:35], v10 offset:49664
    ds_read_b64_tr_b16 v[36:37], v11 offset:49152
    ds_read_b64_tr_b16 v[38:39], v11 offset:49664
    v_mfma_f32_32x32x16_bf16 v[80:95], v[52:55], v[172:175], v[80:95]
    ds_read_b64_tr_b16 v[40:41], v10 offset:51200
    ds_read_b64_tr_b16 v[42:43], v10 offset:51712
    ds_read_b64_tr_b16 v[44:45], v11 offset:51200
    ds_read_b64_tr_b16 v[46:47], v11 offset:51712
    v_mfma_f32_32x32x16_bf16 v[96:111], v[56:59], v[172:175], v[96:111]
    ds_read_b64_tr_b16 v[48:49], v10 offset:53248
    ds_read_b64_tr_b16 v[50:51], v10 offset:53760
    ds_read_b64_tr_b16 v[52:53], v11 offset:53248
    ds_read_b64_tr_b16 v[54:55], v11 offset:53760
    v_mfma_f32_32x32x16_bf16 v[112:127], v[60:63], v[172:175], v[112:127]
    ds_read_b64_tr_b16 v[56:57], v10 offset:55296
    ds_read_b64_tr_b16 v[58:59], v10 offset:55808
    s_waitcnt lgkmcnt(10)
    v_mfma_f32_32x32x16_bf16 v[64:79], v[32:35], v[176:179], v[64:79]
    ds_read_b64_tr_b16 v[60:61], v11 offset:55296
    ds_read_b64_tr_b16 v[62:63], v11 offset:55808
    v_mfma_f32_32x32x16_bf16 v[80:95], v[36:39], v[176:179], v[80:95]
    ds_read_b64_tr_b16 v[32:33], v14 offset:0
    ds_read_b64_tr_b16 v[34:35], v14 offset:512
    s_waitcnt lgkmcnt(10)
    v_mfma_f32_32x32x16_bf16 v[64:79], v[40:43], v[180:183], v[64:79]
    ds_read_b64_tr_b16 v[36:37], v15 offset:0
    ds_read_b64_tr_b16 v[38:39], v15 offset:512
    v_mfma_f32_32x32x16_bf16 v[80:95], v[44:47], v[180:183], v[80:95]
    ds_read_b64_tr_b16 v[40:41], v14 offset:2048
    ds_read_b64_tr_b16 v[42:43], v14 offset:2560
    s_waitcnt lgkmcnt(10)
    v_mfma_f32_32x32x16_bf16 v[64:79], v[48:51], v[184:187], v[64:79]
    ds_read_b64_tr_b16 v[44:45], v15 offset:2048
    ds_read_b64_tr_b16 v[46:47], v15 offset:2560
    v_mfma_f32_32x32x16_bf16 v[80:95], v[52:55], v[184:187], v[80:95]
    ds_read_b64_tr_b16 v[48:49], v14 offset:4096
    ds_read_b64_tr_b16 v[50:51], v14 offset:4608
    s_waitcnt lgkmcnt(10)
    v_mfma_f32_32x32x16_bf16 v[64:79], v[56:59], v[188:191], v[64:79]
    ds_read_b64_tr_b16 v[52:53], v15 offset:4096
    ds_read_b64_tr_b16 v[54:55], v15 offset:4608
    v_mfma_f32_32x32x16_bf16 v[80:95], v[60:63], v[188:191], v[80:95]
    ds_read_b64_tr_b16 v[56:57], v14 offset:6144
    ds_read_b64_tr_b16 v[58:59], v14 offset:6656
    buffer_load_dwordx2 v[240:241], v247, s[60:63], 0 offen sc1
    buffer_load_dwordx2 v[242:243], v247, s[60:63], 0 offen offset:256 sc1
    s_waitcnt lgkmcnt(10)
    v_mfma_f32_32x32x16_bf16 v[64:79], v[32:35], v[192:195], v[64:79]
    ds_read_b64_tr_b16 v[60:61], v15 offset:6144
    ds_read_b64_tr_b16 v[62:63], v15 offset:6656
    v_mfma_f32_32x32x16_bf16 v[80:95], v[36:39], v[192:195], v[80:95]
    ds_read_b64_tr_b16 v[32:33], v14 offset:16384
    ds_read_b64_tr_b16 v[34:35], v14 offset:16896
    s_waitcnt lgkmcnt(10)
    v_mfma_f32_32x32x16_bf16 v[64:79], v[40:43], v[196:199], v[64:79]
    ds_read_b64_tr_b16 v[36:37], v15 offset:16384
    ds_read_b64_tr_b16 v[38:39], v15 offset:16896
    v_mfma_f32_32x32x16_bf16 v[80:95], v[44:47], v[196:199], v[80:95]
    ds_read_b64_tr_b16 v[40:41], v14 offset:18432
    ds_read_b64_tr_b16 v[42:43], v14 offset:18944
    s_waitcnt lgkmcnt(10)
    v_mfma_f32_32x32x16_bf16 v[64:79], v[48:51], v[200:203], v[64:79]
    ds_read_b64_tr_b16 v[44:45], v15 offset:18432
    ds_read_b64_tr_b16 v[46:47], v15 offset:18944
    v_mov_b32 v132, 0
    v_mov_b32 v133, 0
    v_mov_b32 v136, 0
    v_mfma_f32_32x32x16_bf16 v[80:95], v[52:55], v[200:203], v[80:95]
    ds_read_b64_tr_b16 v[48:49], v14 offset:20480
    ds_read_b64_tr_b16 v[50:51], v14 offset:20992
    v_mov_b32 v137, 0
    v_mov_b32 v140, 0
    v_mov_b32 v141, 0
    s_waitcnt lgkmcnt(10)
    v_mfma_f32_32x32x16_bf16 v[64:79], v[56:59], v[204:207], v[64:79]
    ds_read_b64_tr_b16 v[52:53], v15 offset:20480
    ds_read_b64_tr_b16 v[54:55], v15 offset:20992
    s_mov_b32 vcc_lo, -1
    s_mov_b32 vcc_hi, 0
    v_cndmask_b32_e64 v138, v2, 0, vcc
    v_mfma_f32_32x32x16_bf16 v[80:95], v[60:63], v[204:207], v[80:95]
    ds_read_b64_tr_b16 v[56:57], v14 offset:22528
    ds_read_b64_tr_b16 v[58:59], v14 offset:23040
    v_cndmask_b32_e64 v139, v3, 0, vcc
    v_cndmask_b32 v134, 0, v2, vcc
    v_cndmask_b32 v135, 0, v3, vcc
    s_waitcnt lgkmcnt(10)
    v_mfma_f32_32x32x16_bf16 v[64:79], v[32:35], v[208:211], v[64:79]
    ds_read_b64_tr_b16 v[60:61], v15 offset:22528
    ds_read_b64_tr_b16 v[62:63], v15 offset:23040
    v_mfma_f32_32x32x16_bf16 v[80:95], v[36:39], v[208:211], v[80:95]
    ds_read_b64_tr_b16 v[32:33], v14 offset:32768
    ds_read_b64_tr_b16 v[34:35], v14 offset:33280
    s_waitcnt lgkmcnt(10)
    v_mfma_f32_32x32x16_bf16 v[64:79], v[40:43], v[212:215], v[64:79]
    ds_read_b64_tr_b16 v[36:37], v15 offset:32768
    ds_read_b64_tr_b16 v[38:39], v15 offset:33280
    v_mfma_f32_32x32x16_bf16 v[80:95], v[44:47], v[212:215], v[80:95]
    ds_read_b64_tr_b16 v[40:41], v14 offset:34816
    ds_read_b64_tr_b16 v[42:43], v14 offset:35328
    s_waitcnt lgkmcnt(10)
    v_mfma_f32_32x32x16_bf16 v[64:79], v[48:51], v[216:219], v[64:79]
    ds_read_b64_tr_b16 v[44:45], v15 offset:34816
    ds_read_b64_tr_b16 v[46:47], v15 offset:35328
    v_mfma_f32_32x32x16_bf16 v[80:95], v[52:55], v[216:219], v[80:95]
    ds_read_b64_tr_b16 v[48:49], v14 offset:36864
    ds_read_b64_tr_b16 v[50:51], v14 offset:37376
    s_waitcnt lgkmcnt(10)
    v_mfma_f32_32x32x16_bf16 v[64:79], v[56:59], v[220:223], v[64:79]
    ds_read_b64_tr_b16 v[52:53], v15 offset:36864
    ds_read_b64_tr_b16 v[54:55], v15 offset:37376
    v_mfma_f32_32x32x16_bf16 v[80:95], v[60:63], v[220:223], v[80:95]
    ds_read_b64_tr_b16 v[56:57], v14 offset:38912
    ds_read_b64_tr_b16 v[58:59], v14 offset:39424
    s_waitcnt lgkmcnt(10)
    v_mfma_f32_32x32x16_bf16 v[64:79], v[32:35], v[224:227], v[64:79]
    ds_read_b64_tr_b16 v[60:61], v15 offset:38912
    ds_read_b64_tr_b16 v[62:63], v15 offset:39424
    v_mfma_f32_32x32x16_bf16 v[80:95], v[36:39], v[224:227], v[80:95]
    ds_read_b64_tr_b16 v[32:33], v12 offset:49152
    ds_read_b64_tr_b16 v[34:35], v12 offset:49664
    s_waitcnt lgkmcnt(10)
    v_mfma_f32_32x32x16_bf16 v[64:79], v[40:43], v[228:231], v[64:79]
    ds_read_b64_tr_b16 v[36:37], v13 offset:49152
    ds_read_b64_tr_b16 v[38:39], v13 offset:49664
    s_waitcnt vmcnt(0)
    s_mov_b32 s94, 0
PAG_6:
    v_cmp_ne_u32 vcc, s68, v241
    v_cmp_ne_u32 s[90:91], s68, v243
    s_nop 0
    s_or_b64 vcc, vcc, s[90:91]
    s_cbranch_vccz POK_5
    s_add_u32 s94, s94, 1
    s_cmp_gt_u32 s94, 0x40000
    s_cbranch_scc1 POK_5
    s_sleep 2
    buffer_load_dwordx2 v[240:241], v247, s[60:63], 0 offen sc1
    buffer_load_dwordx2 v[242:243], v247, s[60:63], 0 offen offset:256 sc1
    s_waitcnt vmcnt(0)
    s_branch PAG_6
POK_5:
    v_mfma_f32_32x32x16_bf16 v[80:95], v[44:47], v[228:231], v[80:95]
    ds_read_b64_tr_b16 v[40:41], v12 offset:51200
    ds_read_b64_tr_b16 v[42:43], v12 offset:51712
    v_and_b32 v128, 0xffff0000, v240
    v_sub_f32 v240, v240, v128
    v_and_b32 v129, 0xffff0000, v240
    s_waitcnt lgkmcnt(10)
    v_mfma_f32_32x32x16_bf16 v[64:79], v[48:51], v[232:235], v[64:79]
    ds_read_b64_tr_b16 v[44:45], v13 offset:51200
    ds_read_b64_tr_b16 v[46:47], v13 offset:51712
    v_sub_f32 v240, v240, v129
    v_cvt_pk_bf16_f32 v128, v128, v129
    v_cvt_pk_bf16_f32 v129, v240, 0
    v_mfma_f32_32x32x16_bf16 v[80:95], v[52:55], v[232:235], v[80:95]
    ds_read_b64_tr_b16 v[48:49], v12 offset:53248
    ds_read_b64_tr_b16 v[50:51], v12 offset:53760
    v_and_b32 v130, 0xffff0000, v242
    v_sub_f32 v242, v242, v130
    v_and_b32 v131, 0xffff0000, v242
    s_waitcnt lgkmcnt(10)
    v_mfma_f32_32x32x16_bf16 v[64:79], v[56:59], v[236:239], v[64:79]
    ds_read_b64_tr_b16 v[52:53], v13 offset:53248
    ds_read_b64_tr_b16 v[54:55], v13 offset:53760
    v_sub_f32 v242, v242, v131
    v_cvt_pk_bf16_f32 v130, v130, v131
    v_cvt_pk_bf16_f32 v131, v242, 0
    v_mfma_f32_32x32x16_bf16 v[80:95], v[60:63], v[236:239], v[80:95]
    ds_read_b64_tr_b16 v[56:57], v12 offset:55296
    ds_read_b64_tr_b16 v[58:59], v12 offset:55808
    v_mfma_f32_32x32x16_bf16 v[64:79], v[128:131], v[134:137], v[64:79]
    v_mfma_f32_32x32x16_bf16 v[80:95], v[128:131], v[138:141], v[80:95]
    s_waitcnt lgkmcnt(10)
    v_mfma_f32_32x32x16_bf16 v[96:111], v[32:35], v[176:179], v[96:111]
    ds_read_b64_tr_b16 v[60:61], v13 offset:55296
    ds_read_b64_tr_b16 v[62:63], v13 offset:55808
    v_mfma_f32_32x32x16_bf16 v[112:127], v[36:39], v[176:179], v[112:127]
    ds_read_b64_tr_b16 v[32:33], v16 offset:0
    ds_read_b64_tr_b16 v[34:35], v16 offset:512
    s_waitcnt lgkmcnt(10)
    v_mfma_f32_32x32x16_bf16 v[96:111], v[40:43], v[180:183], v[96:111]
    ds_read_b64_tr_b16 v[36:37], v17 offset:0
    ds_read_b64_tr_b16 v[38:39], v17 offset:512
    v_mfma_f32_32x32x16_bf16 v[112:127], v[44:47], v[180:183], v[112:127]
    ds_read_b64_tr_b16 v[40:41], v16 offset:2048
    ds_read_b64_tr_b16 v[42:43], v16 offset:2560
    v_mul_f32 v64, v245, v64
    v_mul_f32 v65, v245, v65
    v_mul_f32 v66, v245, v66
    s_waitcnt lgkmcnt(10)
    v_mfma_f32_32x32x16_bf16 v[96:111], v[48:51], v[184:187], v[96:111]
    ds_read_b64_tr_b16 v[44:45], v17 offset:2048
    ds_read_b64_tr_b16 v[46:47], v17 offset:2560
    v_mul_f32 v67, v245, v67
    v_mul_f32 v68, v245, v68
    v_mul_f32 v69, v245, v69
    v_mfma_f32_32x32x16_bf16 v[112:127], v[52:55], v[184:187], v[112:127]
    ds_read_b64_tr_b16 v[48:49], v16 offset:4096
    ds_read_b64_tr_b16 v[50:51], v16 offset:4608
    v_mul_f32 v70, v245, v70
    v_mul_f32 v71, v245, v71
    s_waitcnt lgkmcnt(10)
    v_mfma_f32_32x32x16_bf16 v[96:111], v[56:59], v[188:191], v[96:111]
    ds_read_b64_tr_b16 v[52:53], v17 offset:4096
    ds_read_b64_tr_b16 v[54:55], v17 offset:4608
    v_exp_f32 v64, v64
    v_mfma_f32_32x32x16_bf16 v[112:127], v[60:63], v[188:191], v[112:127]
    ds_read_b64_tr_b16 v[56:57], v16 offset:6144
    ds_read_b64_tr_b16 v[58:59], v16 offset:6656
    v_exp_f32 v65, v65
    s_waitcnt lgkmcnt(10)
    v_mfma_f32_32x32x16_bf16 v[96:111], v[32:35], v[192:195], v[96:111]
    ds_read_b64_tr_b16 v[60:61], v17 offset:6144
    ds_read_b64_tr_b16 v[62:63], v17 offset:6656
    v_exp_f32 v66, v66
    v_mfma_f32_32x32x16_bf16 v[112:127], v[36:39], v[192:195], v[112:127]
    v_exp_f32 v67, v67
    v_exp_f32 v68, v68
    s_waitcnt lgkmcnt(8)
    v_mfma_f32_32x32x16_bf16 v[96:111], v[40:43], v[196:199], v[96:111]
    v_exp_f32 v69, v69
    v_exp_f32 v70, v70
    v_mfma_f32_32x32x16_bf16 v[112:127], v[44:47], v[196:199], v[112:127]
    v_exp_f32 v71, v71
    v_fma_f32 v64, v64, v244, v244
    v_fma_f32 v65, v65, v244, v244
    v_fma_f32 v66, v66, v244, v244
    s_waitcnt lgkmcnt(0)
    v_mfma_f32_32x32x16_bf16 v[96:111], v[48:51], v[200:203], v[96:111]
    s_barrier
    ds_read_b64_tr_b16 v[32:33], v16 offset:16384
    ds_read_b64_tr_b16 v[34:35], v16 offset:16896
    ds_read_b64_tr_b16 v[36:37], v17 offset:16384
    ds_read_b64_tr_b16 v[38:39], v17 offset:16896
    v_fma_f32 v67, v67, v244, v244
    v_mfma_f32_32x32x16_bf16 v[112:127], v[52:55], v[200:203], v[112:127]
    ds_read_b64_tr_b16 v[40:41], v16 offset:18432
    ds_read_b64_tr_b16 v[42:43], v16 offset:18944
    ds_read_b64_tr_b16 v[44:45], v17 offset:18432
    ds_read_b64_tr_b16 v[46:47], v17 offset:18944
    v_fma_f32 v68, v68, v244, v244
    v_mfma_f32_32x32x16_bf16 v[96:111], v[56:59], v[204:207], v[96:111]
    ds_read_b64_tr_b16 v[48:49], v16 offset:20480
    ds_read_b64_tr_b16 v[50:51], v16 offset:20992
    ds_read_b64_tr_b16 v[52:53], v17 offset:20480
    ds_read_b64_tr_b16 v[54:55], v17 offset:20992
    v_fma_f32 v69, v69, v244, v244
    v_mfma_f32_32x32x16_bf16 v[112:127], v[60:63], v[204:207], v[112:127]
    ds_read_b64_tr_b16 v[56:57], v16 offset:22528
    ds_read_b64_tr_b16 v[58:59], v16 offset:23040
    v_fma_f32 v70, v70, v244, v244
    v_fma_f32 v71, v71, v244, v244
    s_waitcnt lgkmcnt(10)
    v_mfma_f32_32x32x16_bf16 v[96:111], v[32:35], v[208:211], v[96:111]
    ds_read_b64_tr_b16 v[60:61], v17 offset:22528
    ds_read_b64_tr_b16 v[62:63], v17 offset:23040
    v_rcp_f32 v64, v64
    v_mfma_f32_32x32x16_bf16 v[112:127], v[36:39], v[208:211], v[112:127]
    ds_read_b64_tr_b16 v[32:33], v16 offset:32768
    ds_read_b64_tr_b16 v[34:35], v16 offset:33280
    v_rcp_f32 v65, v65
    s_waitcnt lgkmcnt(10)
    v_mfma_f32_32x32x16_bf16 v[96:111], v[40:43], v[212:215], v[96:111]
    ds_read_b64_tr_b16 v[36:37], v17 offset:32768
    ds_read_b64_tr_b16 v[38:39], v17 offset:33280
    v_rcp_f32 v66, v66
    v_mfma_f32_32x32x16_bf16 v[112:127], v[44:47], v[212:215], v[112:127]
    ds_read_b64_tr_b16 v[40:41], v16 offset:34816
    ds_read_b64_tr_b16 v[42:43], v16 offset:35328
    v_rcp_f32 v67, v67
    s_waitcnt lgkmcnt(10)
    v_mfma_f32_32x32x16_bf16 v[96:111], v[48:51], v[216:219], v[96:111]
    ds_read_b64_tr_b16 v[44:45], v17 offset:34816
    ds_read_b64_tr_b16 v[46:47], v17 offset:35328
    v_rcp_f32 v68, v68
    v_mfma_f32_32x32x16_bf16 v[112:127], v[52:55], v[216:219], v[112:127]
    ds_read_b64_tr_b16 v[48:49], v16 offset:36864
    ds_read_b64_tr_b16 v[50:51], v16 offset:37376
    v_rcp_f32 v69, v69
    s_waitcnt lgkmcnt(10)
    v_mfma_f32_32x32x16_bf16 v[96:111], v[56:59], v[220:223], v[96:111]
    ds_read_b64_tr_b16 v[52:53], v17 offset:36864
    ds_read_b64_tr_b16 v[54:55], v17 offset:37376
    v_rcp_f32 v70, v70
    v_mfma_f32_32x32x16_bf16 v[112:127], v[60:63], v[220:223], v[112:127]
    ds_read_b64_tr_b16 v[56:57], v16 offset:38912
    ds_read_b64_tr_b16 v[58:59], v16 offset:39424
    v_rcp_f32 v71, v71
    v_mul_f32 v72, v72, v64
    s_waitcnt lgkmcnt(10)
    v_mfma_f32_32x32x16_bf16 v[96:111], v[32:35], v[224:227], v[96:111]
    ds_read_b64_tr_b16 v[60:61], v17 offset:38912
    ds_read_b64_tr_b16 v[62:63], v17 offset:39424
    v_mul_f32 v73, v73, v65
    v_mul_f32 v74, v74, v66
    v_mul_f32 v75, v75, v67
    v_mfma_f32_32x32x16_bf16 v[112:127], v[36:39], v[224:227], v[112:127]
    v_mul_f32 v76, v76, v68
    v_mul_f32 v77, v77, v69
    v_mul_f32 v78, v78, v70
    v_mul_f32 v79, v79, v71
    v_cvt_pk_bf16_f32 v64, v72, v73
    s_waitcnt lgkmcnt(8)
    v_mfma_f32_32x32x16_bf16 v[96:111], v[40:43], v[228:231], v[96:111]
    v_cvt_pk_bf16_f32 v65, v74, v75
    v_cvt_pk_bf16_f32 v66, v76, v77
    v_cvt_pk_bf16_f32 v67, v78, v79
    v_mul_f32 v80, v245, v80
    v_mul_f32 v81, v245, v81
    v_mfma_f32_32x32x16_bf16 v[112:127], v[44:47], v[228:231], v[112:127]
    v_mul_f32 v82, v245, v82
    v_mul_f32 v83, v245, v83
    v_mul_f32 v84, v245, v84
    v_mul_f32 v85, v245, v85
    v_mul_f32 v86, v245, v86
    s_waitcnt lgkmcnt(0)
    v_mfma_f32_32x32x16_bf16 v[96:111], v[48:51], v[232:235], v[96:111]
    s_barrier
    v_mul_f32 v87, v245, v87
    v_exp_f32 v80, v80
    v_exp_f32 v81, v81
    v_mfma_f32_32x32x16_bf16 v[112:127], v[52:55], v[232:235], v[112:127]
    v_exp_f32 v82, v82
    v_exp_f32 v83, v83
    v_mfma_f32_32x32x16_bf16 v[96:111], v[56:59], v[236:239], v[96:111]
    v_exp_f32 v84, v84
    v_exp_f32 v85, v85
    v_mfma_f32_32x32x16_bf16 v[112:127], v[60:63], v[236:239], v[112:127]
    v_exp_f32 v86, v86
    v_exp_f32 v87, v87
    v_fma_f32 v80, v80, v244, v244
    v_mfma_f32_32x32x16_bf16 v[96:111], v[130:133], v[134:137], v[96:111]
    v_mfma_f32_32x32x16_bf16 v[112:127], v[130:133], v[138:141], v[112:127]
    buffer_store_dwordx4 v[64:67], v248, s[60:63], s95 offen offset:0 sc1
    v_fma_f32 v81, v81, v244, v244
    v_fma_f32 v82, v82, v244, v244
    v_fma_f32 v83, v83, v244, v244
    v_fma_f32 v84, v84, v244, v244
    v_fma_f32 v85, v85, v244, v244
    v_fma_f32 v86, v86, v244, v244
    v_fma_f32 v87, v87, v244, v244
    v_rcp_f32 v80, v80
    v_rcp_f32 v81, v81
    v_rcp_f32 v82, v82
    v_rcp_f32 v83, v83
    v_rcp_f32 v84, v84
    v_rcp_f32 v85, v85
    v_rcp_f32 v86, v86
    v_rcp_f32 v87, v87
    v_mul_f32 v88, v88, v80
    v_mul_f32 v89, v89, v81
    v_mul_f32 v90, v90, v82
    v_mul_f32 v91, v91, v83
    v_mul_f32 v92, v92, v84
    v_mul_f32 v93, v93, v85
    v_mul_f32 v94, v94, v86
    v_mul_f32 v95, v95, v87
    v_cvt_pk_bf16_f32 v80, v88, v89
    v_cvt_pk_bf16_f32 v81, v90, v91
    v_cvt_pk_bf16_f32 v82, v92, v93
    v_cvt_pk_bf16_f32 v83, v94, v95
    buffer_store_dwordx4 v[80:83], v248, s[60:63], s95 offen offset:1024 sc1
    v_mul_f32 v96, v245, v96
    v_mul_f32 v97, v245, v97
    v_mul_f32 v98, v245, v98
    v_mul_f32 v99, v245, v99
    v_mul_f32 v100, v245, v100
    v_mul_f32 v101, v245, v101
    v_mul_f32 v102, v245, v102
    v_mul_f32 v103, v245, v103
    v_exp_f32 v96, v96
    v_exp_f32 v97, v97
    v_exp_f32 v98, v98
    v_exp_f32 v99, v99
    v_exp_f32 v100, v100
    v_exp_f32 v101, v101
    v_exp_f32 v102, v102
    v_exp_f32 v103, v103
    v_fma_f32 v96, v96, v244, v244
    v_fma_f32 v97, v97, v244, v244
    v_fma_f32 v98, v98, v244, v244
    v_fma_f32 v99, v99, v244, v244
    buffer_load_dword v251, v252, s[60:63], 0 offen offset:0 sc1
    v_fma_f32 v100, v100, v244, v244
    v_fma_f32 v101, v101, v244, v244
    v_fma_f32 v102, v102, v244, v244
    v_fma_f32 v103, v103, v244, v244
    v_rcp_f32 v96, v96
    v_rcp_f32 v97, v97
    v_rcp_f32 v98, v98
    v_rcp_f32 v99, v99
    v_rcp_f32 v100, v100
    v_rcp_f32 v101, v101
    v_rcp_f32 v102, v102
    v_rcp_f32 v103, v103
    v_mul_f32 v104, v104, v96
    v_mul_f32 v105, v105, v97
    v_mul_f32 v106, v106, v98
    v_mul_f32 v107, v107, v99
    v_mul_f32 v108, v108, v100
    v_mul_f32 v109, v109, v101
    v_mul_f32 v110, v110, v102
    v_mul_f32 v111, v111, v103
    v_cvt_pk_bf16_f32 v96, v104, v105
    v_cvt_pk_bf16_f32 v97, v106, v107
    v_cvt_pk_bf16_f32 v98, v108, v109
    v_cvt_pk_bf16_f32 v99, v110, v111
    buffer_store_dwordx4 v[96:99], v248, s[60:63], s95 offen offset:2048 sc1
    v_mul_f32 v112, v245, v112
    v_mul_f32 v113, v245, v113
    v_mul_f32 v114, v245, v114
    v_mul_f32 v115, v245, v115
    v_mul_f32 v116, v245, v116
    v_mul_f32 v117, v245, v117
    v_mul_f32 v118, v245, v118
    v_mul_f32 v119, v245, v119
    v_exp_f32 v112, v112
    v_exp_f32 v113, v113
    v_exp_f32 v114, v114
    v_exp_f32 v115, v115
    v_exp_f32 v116, v116
    v_exp_f32 v117, v117
    v_exp_f32 v118, v118
    v_exp_f32 v119, v119
    v_fma_f32 v112, v112, v244, v244
    v_fma_f32 v113, v113, v244, v244
    v_fma_f32 v114, v114, v244, v244
    v_fma_f32 v115, v115, v244, v244
    v_fma_f32 v116, v116, v244, v244
    v_fma_f32 v117, v117, v244, v244
    v_fma_f32 v118, v118, v244, v244
    v_fma_f32 v119, v119, v244, v244
    v_rcp_f32 v112, v112
    v_rcp_f32 v113, v113
    v_rcp_f32 v114, v114
    v_rcp_f32 v115, v115
    v_rcp_f32 v116, v116
    v_rcp_f32 v117, v117
    v_rcp_f32 v118, v118
    v_rcp_f32 v119, v119
    v_mul_f32 v120, v120, v112
    v_mul_f32 v121, v121, v113
    v_mul_f32 v122, v122, v114
    v_mul_f32 v123, v123, v115
    v_mul_f32 v124, v124, v116
    v_mul_f32 v125, v125, v117
    v_mul_f32 v126, v126, v118
    v_mul_f32 v127, v127, v119
    v_cvt_pk_bf16_f32 v112, v120, v121
    v_cvt_pk_bf16_f32 v113, v122, v123
    v_cvt_pk_bf16_f32 v114, v124, v125
    v_cvt_pk_bf16_f32 v115, v126, v127
    buffer_store_dwordx4 v[112:115], v248, s[60:63], s95 offen offset:3072 sc1
    s_waitcnt vmcnt(2)
    s_mov_b32 s94, 0
PAG_11:
    v_cmp_ne_u32 vcc, s68, v251
    s_cbranch_vccz POK_10
    s_add_u32 s94, s94, 1
    s_cmp_gt_u32 s94, 0x40000
    s_cbranch_scc1 POK_10
    s_sleep 2
    buffer_load_dword v251, v252, s[60:63], 0 offen offset:0 sc1
    s_waitcnt vmcnt(0)
    s_branch PAG_11
POK_10:
    s_lshl_b32 s91, s80, 14
    s_add_u32 s91, s91, s97
    buffer_load_dwordx4 v[128:131], v248, s[60:63], s91 offen offset:0 sc1
    buffer_load_dwordx4 v[132:135], v248, s[60:63], s91 offen offset:1024 sc1
    buffer_load_dwordx4 v[136:139], v248, s[60:63], s91 offen offset:2048 sc1
    buffer_load_dwordx4 v[140:143], v248, s[60:63], s91 offen offset:3072 sc1
    s_lshl_b32 s91, s81, 14
    s_add_u32 s91, s91, s97
    buffer_load_dwordx4 v[144:147], v248, s[60:63], s91 offen offset:0 sc1
    buffer_load_dwordx4 v[148:151], v248, s[60:63], s91 offen offset:1024 sc1
    buffer_load_dwordx4 v[152:155], v248, s[60:63], s91 offen offset:2048 sc1
    buffer_load_dwordx4 v[156:159], v248, s[60:63], s91 offen offset:3072 sc1
    s_lshl_b32 s91, s82, 14
    s_add_u32 s91, s91, s97
    buffer_load_dwordx4 v[160:163], v248, s[60:63], s91 offen offset:0 sc1
    buffer_load_dwordx4 v[164:167], v248, s[60:63], s91 offen offset:1024 sc1
    s_waitcnt vmcnt(10)
    v_lshrrev_b32 v250, 5, v1
    v_mul_u32_u24 v250, 1920, v250
    v_lshl_add_u32 v249, v1, 2, v250
    v_mov_b32 v250, s68
    s_mov_b32 exec_lo, 0xff
    s_mov_b32 exec_hi, 0
    buffer_store_dword v250, v249, s[60:63], s96 offen offset:0 sc1
    s_mov_b64 exec, -1
    buffer_load_dwordx4 v[168:171], v248, s[60:63], s91 offen offset:2048 sc1
    buffer_load_dwordx4 v[172:175], v248, s[60:63], s91 offen offset:3072 sc1
    s_lshl_b32 s91, s83, 14
    s_add_u32 s91, s91, s97
    buffer_load_dwordx4 v[176:179], v248, s[60:63], s91 offen offset:0 sc1
    buffer_load_dwordx4 v[180:183], v248, s[60:63], s91 offen offset:1024 sc1
    buffer_load_dwordx4 v[184:187], v248, s[60:63], s91 offen offset:2048 sc1
    buffer_load_dwordx4 v[188:191], v248, s[60:63], s91 offen offset:3072 sc1
    s_lshl_b32 s91, s84, 14
    s_add_u32 s91, s91, s97
    buffer_load_dwordx4 v[192:195], v248, s[60:63], s91 offen offset:0 sc1
    buffer_load_dwordx4 v[196:199], v248, s[60:63], s91 offen offset:1024 sc1
    buffer_load_dwordx4 v[200:203], v248, s[60:63], s91 offen offset:2048 sc1
    buffer_load_dwordx4 v[204:207], v248, s[60:63], s91 offen offset:3072 sc1
    s_barrier
    ds_read_b64_tr_b16 v[96:97], v28 offset:0
    ds_read_b64_tr_b16 v[98:99], v28 offset:512
    ds_read_b64_tr_b16 v[100:101], v29 offset:0
    ds_read_b64_tr_b16 v[102:103], v29 offset:512
    ds_read_b64_tr_b16 v[104:105], v28 offset:2048
    ds_read_b64_tr_b16 v[106:107], v28 offset:2560
    ds_read_b64_tr_b16 v[108:109], v29 offset:2048
    ds_read_b64_tr_b16 v[110:111], v29 offset:2560
    s_waitcnt vmcnt(20)
    s_waitcnt lgkmcnt(4)
    v_mfma_f32_32x32x16_bf16 v[64:79], v[96:99], v[128:131], 0
    ds_read_b64_tr_b16 v[112:113], v28 offset:4096
    ds_read_b64_tr_b16 v[114:115], v28 offset:4608
    ds_read_b64_tr_b16 v[116:117], v29 offset:4096
    ds_read_b64_tr_b16 v[118:119], v29 offset:4608
    v_mfma_f32_32x32x16_bf16 v[80:95], v[100:103], v[128:131], 0
    s_lshl_b32 s91, s85, 14
    s_add_u32 s91, s91, s97
    buffer_load_dwordx4 v[208:211], v248, s[60:63], s91 offen offset:0 sc1
    s_waitcnt vmcnt(20)
    s_waitcnt lgkmcnt(4)
    v_mfma_f32_32x32x16_bf16 v[64:79], v[104:107], v[132:135], v[64:79]
    ds_read_b64_tr_b16 v[120:121], v28 offset:6144
    ds_read_b64_tr_b16 v[122:123], v28 offset:6656
    ds_read_b64_tr_b16 v[124:125], v29 offset:6144
    ds_read_b64_tr_b16 v[126:127], v29 offset:6656
    v_mfma_f32_32x32x16_bf16 v[80:95], v[108:111], v[132:135], v[80:95]
    buffer_load_dwordx4 v[212:215], v248, s[60:63], s91 offen offset:1024 sc1
    s_waitcnt vmcnt(20)
    s_waitcnt lgkmcnt(0)
    v_mfma_f32_32x32x16_bf16 v[64:79], v[112:115], v[136:139], v[64:79]
    s_barrier
    ds_read_b64_tr_b16 v[96:97], v28 offset:16384
    ds_read_b64_tr_b16 v[98:99], v28 offset:16896
    ds_read_b64_tr_b16 v[100:101], v29 offset:16384
    ds_read_b64_tr_b16 v[102:103], v29 offset:16896
    v_mfma_f32_32x32x16_bf16 v[80:95], v[116:119], v[136:139], v[80:95]
    buffer_load_dwordx4 v[216:219], v248, s[60:63], s91 offen offset:2048 sc1
    s_waitcnt vmcnt(20)
    v_mfma_f32_32x32x16_bf16 v[64:79], v[120:123], v[140:143], v[64:79]
    ds_read_b64_tr_b16 v[104:105], v28 offset:18432
    ds_read_b64_tr_b16 v[106:107], v28 offset:18944
    ds_read_b64_tr_b16 v[108:109], v29 offset:18432
    ds_read_b64_tr_b16 v[110:111], v29 offset:18944
    v_mfma_f32_32x32x16_bf16 v[80:95], v[124:127], v[140:143], v[80:95]
    buffer_load_dwordx4 v[220:223], v248, s[60:63], s91 offen offset:3072 sc1
    s_waitcnt vmcnt(20)
    s_waitcnt lgkmcnt(4)
    v_mfma_f32_32x32x16_bf16 v[64:79], v[96:99], v[144:147], v[64:79]
    ds_read_b64_tr_b16 v[112:113], v28 offset:20480
    ds_read_b64_tr_b16 v[114:115], v28 offset:20992
    ds_read_b64_tr_b16 v[116:117], v29 offset:20480
    ds_read_b64_tr_b16 v[118:119], v29 offset:20992
    v_mfma_f32_32x32x16_bf16 v[80:95], v[100:103], v[144:147], v[80:95]
    s_lshl_b32 s91, s86, 14
    s_add_u32 s91, s91, s97
    s_add_u32 s97, s97, 4096
    buffer_load_dwordx4 v[224:227], v248, s[60:63], s91 offen offset:0 sc1
    s_waitcnt vmcnt(20)
    s_waitcnt lgkmcnt(4)
    v_mfma_f32_32x32x16_bf16 v[64:79], v[104:107], v[148:151], v[64:79]
    ds_read_b64_tr_b16 v[120:121], v28 offset:22528
    ds_read_b64_tr_b16 v[122:123], v28 offset:23040
    ds_read_b64_tr_b16 v[124:125], v29 offset:22528
    ds_read_b64_tr_b16 v[126:127], v29 offset:23040
    v_mfma_f32_32x32x16_bf16 v[80:95], v[108:111], v[148:151], v[80:95]
    buffer_load_dwordx4 v[228:231], v248, s[60:63], s91 offen offset:1024 sc1
    s_waitcnt vmcnt(20)
    s_waitcnt lgkmcnt(4)
    v_mfma_f32_32x32x16_bf16 v[64:79], v[112:115], v[152:155], v[64:79]
    ds_read_b64_tr_b16 v[96:97], v28 offset:32768
    ds_read_b64_tr_b16 v[98:99], v28 offset:33280
    ds_read_b64_tr_b16 v[100:101], v29 offset:32768
    ds_read_b64_tr_b16 v[102:103], v29 offset:33280
    v_mfma_f32_32x32x16_bf16 v[80:95], v[116:119], v[152:155], v[80:95]
    buffer_load_dwordx4 v[232:235], v248, s[60:63], s91 offen offset:2048 sc1
    s_waitcnt vmcnt(20)
    s_waitcnt lgkmcnt(4)
    v_mfma_f32_32x32x16_bf16 v[64:79], v[120:123], v[156:159], v[64:79]
    ds_read_b64_tr_b16 v[104:105], v28 offset:34816
    ds_read_b64_tr_b16 v[106:107], v28 offset:35328
    ds_read_b64_tr_b16 v[108:109], v29 offset:34816
    ds_read_b64_tr_b16 v[110:111], v29 offset:35328
    v_mfma_f32_32x32x16_bf16 v[80:95], v[124:127], v[156:159], v[80:95]
    buffer_load_dwordx4 v[236:239], v248, s[60:63], s91 offen offset:3072 sc1
    s_waitcnt vmcnt(20)
    s_waitcnt lgkmcnt(4)
    v_mfma_f32_32x32x16_bf16 v[64:79], v[96:99], v[160:163], v[64:79]
    ds_read_b64_tr_b16 v[112:113], v28 offset:36864
    ds_read_b64_tr_b16 v[114:115], v28 offset:37376
    v_mfma_f32_32x32x16_bf16 v[80:95], v[100:103], v[160:163], v[80:95]
    ds_read_b64_tr_b16 v[116:117], v29 offset:36864
    ds_read_b64_tr_b16 v[118:119], v29 offset:37376
    s_waitcnt vmcnt(19)
    s_waitcnt lgkmcnt(4)
    v_mfma_f32_32x32x16_bf16 v[64:79], v[104:107], v[164:167], v[64:79]
    ds_read_b64_tr_b16 v[120:121], v28 offset:38912
    ds_read_b64_tr_b16 v[122:123], v28 offset:39424
    v_mfma_f32_32x32x16_bf16 v[80:95], v[108:111], v[164:167], v[80:95]
    ds_read_b64_tr_b16 v[124:125], v29 offset:38912
    ds_read_b64_tr_b16 v[126:127], v29 offset:39424
    s_waitcnt vmcnt(17)
    s_waitcnt lgkmcnt(4)
    v_mfma_f32_32x32x16_bf16 v[64:79], v[112:115], v[168:171], v[64:79]
    ds_read_b64_tr_b16 v[96:97], v28 offset:49152
    ds_read_b64_tr_b16 v[98:99], v28 offset:49664
    v_mfma_f32_32x32x16_bf16 v[80:95], v[116:119], v[168:171], v[80:95]
    ds_read_b64_tr_b16 v[100:101], v29 offset:49152
    ds_read_b64_tr_b16 v[102:103], v29 offset:49664
    s_waitcnt vmcnt(16)
    s_waitcnt lgkmcnt(4)
    v_mfma_f32_32x32x16_bf16 v[64:79], v[120:123], v[172:175], v[64:79]
    ds_read_b64_tr_b16 v[104:105], v28 offset:51200
    ds_read_b64_tr_b16 v[106:107], v28 offset:51712
    v_mfma_f32_32x32x16_bf16 v[80:95], v[124:127], v[172:175], v[80:95]
    ds_read_b64_tr_b16 v[108:109], v29 offset:51200
    ds_read_b64_tr_b16 v[110:111], v29 offset:51712
    s_waitcnt vmcnt(15)
    s_waitcnt lgkmcnt(4)
    v_mfma_f32_32x32x16_bf16 v[64:79], v[96:99], v[176:179], v[64:79]
    ds_read_b64_tr_b16 v[112:113], v28 offset:53248
    ds_read_b64_tr_b16 v[114:115], v28 offset:53760
    v_mfma_f32_32x32x16_bf16 v[80:95], v[100:103], v[176:179], v[80:95]
    ds_read_b64_tr_b16 v[116:117], v29 offset:53248
    ds_read_b64_tr_b16 v[118:119], v29 offset:53760
    s_waitcnt vmcnt(14)
    s_waitcnt lgkmcnt(4)
    v_mfma_f32_32x32x16_bf16 v[64:79], v[104:107], v[180:183], v[64:79]
    ds_read_b64_tr_b16 v[120:121], v28 offset:55296
    ds_read_b64_tr_b16 v[122:123], v28 offset:55808
    v_mfma_f32_32x32x16_bf16 v[80:95], v[108:111], v[180:183], v[80:95]
    ds_read_b64_tr_b16 v[124:125], v29 offset:55296
    ds_read_b64_tr_b16 v[126:127], v29 offset:55808
    s_waitcnt vmcnt(13)
    s_waitcnt lgkmcnt(4)
    v_mfma_f32_32x32x16_bf16 v[64:79], v[112:115], v[184:187], v[64:79]
    ds_read_b64_tr_b16 v[96:97], v30 offset:0
    ds_read_b64_tr_b16 v[98:99], v30 offset:512
    v_mfma_f32_32x32x16_bf16 v[80:95], v[116:119], v[184:187], v[80:95]
    ds_read_b64_tr_b16 v[100:101], v31 offset:0
    ds_read_b64_tr_b16 v[102:103], v31 offset:512
    s_waitcnt vmcnt(12)
    s_waitcnt lgkmcnt(4)
    v_mfma_f32_32x32x16_bf16 v[64:79], v[120:123], v[188:191], v[64:79]
    ds_read_b64_tr_b16 v[104:105], v30 offset:2048
    ds_read_b64_tr_b16 v[106:107], v30 offset:2560
    v_mfma_f32_32x32x16_bf16 v[80:95], v[124:127], v[188:191], v[80:95]
    ds_read_b64_tr_b16 v[108:109], v31 offset:2048
    ds_read_b64_tr_b16 v[110:111], v31 offset:2560
    s_waitcnt vmcnt(11)
    s_waitcnt lgkmcnt(4)
    v_mfma_f32_32x32x16_bf16 v[64:79], v[96:99], v[192:195], v[64:79]
    ds_read_b64_tr_b16 v[112:113], v30 offset:4096
    ds_read_b64_tr_b16 v[114:115], v30 offset:4608
    v_mfma_f32_32x32x16_bf16 v[80:95], v[100:103], v[192:195], v[80:95]
    ds_read_b64_tr_b16 v[116:117], v31 offset:4096
    ds_read_b64_tr_b16 v[118:119], v31 offset:4608
    s_waitcnt vmcnt(10)
    s_waitcnt lgkmcnt(4)
    v_mfma_f32_32x32x16_bf16 v[64:79], v[104:107], v[196:199], v[64:79]
    ds_read_b64_tr_b16 v[120:121], v30 offset:6144
    ds_read_b64_tr_b16 v[122:123], v30 offset:6656
    v_mfma_f32_32x32x16_bf16 v[80:95], v[108:111], v[196:199], v[80:95]
    ds_read_b64_tr_b16 v[124:125], v31 offset:6144
    ds_read_b64_tr_b16 v[126:127], v31 offset:6656
    s_waitcnt vmcnt(9)
    s_waitcnt lgkmcnt(4)
    v_mfma_f32_32x32x16_bf16 v[64:79], v[112:115], v[200:203], v[64:79]
    ds_read_b64_tr_b16 v[96:97], v30 offset:16384
    ds_read_b64_tr_b16 v[98:99], v30 offset:16896
    v_mfma_f32_32x32x16_bf16 v[80:95], v[116:119], v[200:203], v[80:95]
    ds_read_b64_tr_b16 v[100:101], v31 offset:16384
    ds_read_b64_tr_b16 v[102:103], v31 offset:16896
    s_waitcnt vmcnt(8)
    s_waitcnt lgkmcnt(4)
    v_mfma_f32_32x32x16_bf16 v[64:79], v[120:123], v[204:207], v[64:79]
    ds_read_b64_tr_b16 v[104:105], v30 offset:18432
    ds_read_b64_tr_b16 v[106:107], v30 offset:18944
    v_mfma_f32_32x32x16_bf16 v[80:95], v[124:127], v[204:207], v[80:95]
    ds_read_b64_tr_b16 v[108:109], v31 offset:18432
    ds_read_b64_tr_b16 v[110:111], v31 offset:18944
    s_waitcnt vmcnt(7)
    s_waitcnt lgkmcnt(0)
    v_mfma_f32_32x32x16_bf16 v[64:79], v[96:99], v[208:211], v[64:79]
    s_barrier
    ds_read_b64_tr_b16 v[112:113], v30 offset:20480
    ds_read_b64_tr_b16 v[114:115], v30 offset:20992
    ds_read_b64_tr_b16 v[116:117], v31 offset:20480
    ds_read_b64_tr_b16 v[118:119], v31 offset:20992
    v_mfma_f32_32x32x16_bf16 v[80:95], v[100:103], v[208:211], v[80:95]
    s_lshl_b32 s91, s80, 14
    s_add_u32 s91, s91, s97
    buffer_load_dwordx4 v[128:131], v248, s[60:63], s91 offen offset:0 sc1
    buffer_load_dwordx4 v[132:135], v248, s[60:63], s91 offen offset:1024 sc1
    s_waitcnt vmcnt(8)
    v_mfma_f32_32x32x16_bf16 v[64:79], v[104:107], v[212:215], v[64:79]
    ds_read_b64_tr_b16 v[120:121], v30 offset:22528
    ds_read_b64_tr_b16 v[122:123], v30 offset:23040
    ds_read_b64_tr_b16 v[124:125], v31 offset:22528
    ds_read_b64_tr_b16 v[126:127], v31 offset:23040
    v_mfma_f32_32x32x16_bf16 v[80:95], v[108:111], v[212:215], v[80:95]
    buffer_load_dwordx4 v[136:139], v248, s[60:63], s91 offen offset:2048 sc1
    buffer_load_dwordx4 v[140:143], v248, s[60:63], s91 offen offset:3072 sc1
    s_waitcnt vmcnt(9)
    s_waitcnt lgkmcnt(4)
    v_mfma_f32_32x32x16_bf16 v[64:79], v[112:115], v[216:219], v[64:79]
    ds_read_b64_tr_b16 v[96:97], v30 offset:32768
    ds_read_b64_tr_b16 v[98:99], v30 offset:33280
    ds_read_b64_tr_b16 v[100:101], v31 offset:32768
    ds_read_b64_tr_b16 v[102:103], v31 offset:33280
    v_mfma_f32_32x32x16_bf16 v[80:95], v[116:119], v[216:219], v[80:95]
    s_lshl_b32 s91, s81, 14
    s_add_u32 s91, s91, s97
    buffer_load_dwordx4 v[144:147], v248, s[60:63], s91 offen offset:0 sc1
    buffer_load_dwordx4 v[148:151], v248, s[60:63], s91 offen offset:1024 sc1
    s_waitcnt vmcnt(10)
    s_waitcnt lgkmcnt(4)
    v_mfma_f32_32x32x16_bf16 v[64:79], v[120:123], v[220:223], v[64:79]
    ds_read_b64_tr_b16 v[104:105], v30 offset:34816
    ds_read_b64_tr_b16 v[106:107], v30 offset:35328
    ds_read_b64_tr_b16 v[108:109], v31 offset:34816
    ds_read_b64_tr_b16 v[110:111], v31 offset:35328
    v_mfma_f32_32x32x16_bf16 v[80:95], v[124:127], v[220:223], v[80:95]
    buffer_load_dwordx4 v[152:155], v248, s[60:63], s91 offen offset:2048 sc1
    buffer_load_dwordx4 v[156:159], v248, s[60:63], s91 offen offset:3072 sc1
    s_waitcnt vmcnt(11)
    s_waitcnt lgkmcnt(4)
    v_mfma_f32_32x32x16_bf16 v[64:79], v[96:99], v[224:227], v[64:79]
    ds_read_b64_tr_b16 v[112:113], v30 offset:36864
    ds_read_b64_tr_b16 v[114:115], v30 offset:37376
    ds_read_b64_tr_b16 v[116:117], v31 offset:36864
    ds_read_b64_tr_b16 v[118:119], v31 offset:37376
    v_mfma_f32_32x32x16_bf16 v[80:95], v[100:103], v[224:227], v[80:95]
    s_lshl_b32 s91, s82, 14
    s_add_u32 s91, s91, s97
    buffer_load_dwordx4 v[160:163], v248, s[60:63], s91 offen offset:0 sc1
    buffer_load_dwordx4 v[164:167], v248, s[60:63], s91 offen offset:1024 sc1
    s_waitcnt vmcnt(12)
    s_waitcnt lgkmcnt(4)
    v_mfma_f32_32x32x16_bf16 v[64:79], v[104:107], v[228:231], v[64:79]
    ds_read_b64_tr_b16 v[120:121], v30 offset:38912
    ds_read_b64_tr_b16 v[122:123], v30 offset:39424
    ds_read_b64_tr_b16 v[124:125], v31 offset:38912
    ds_read_b64_tr_b16 v[126:127], v31 offset:39424
    v_mfma_f32_32x32x16_bf16 v[80:95], v[108:111], v[228:231], v[80:95]
    buffer_load_dwordx4 v[168:171], v248, s[60:63], s91 offen offset:2048 sc1
    buffer_load_dwordx4 v[172:175], v248, s[60:63], s91 offen offset:3072 sc1
    s_waitcnt vmcnt(13)
    s_waitcnt lgkmcnt(0)
    v_mfma_f32_32x32x16_bf16 v[64:79], v[112:115], v[232:235], v[64:79]
    s_barrier
    ds_read_b64_tr_b16 v[96:97], v26 offset:0
    ds_read_b64_tr_b16 v[98:99], v26 offset:512
    ds_read_b64_tr_b16 v[100:101], v27 offset:0
    ds_read_b64_tr_b16 v[102:103], v27 offset:512
    v_mfma_f32_32x32x16_bf16 v[80:95], v[116:119], v[232:235], v[80:95]
    s_lshl_b32 s91, s83, 14
    s_add_u32 s91, s91, s97
    buffer_load_dwordx4 v[176:179], v248, s[60:63], s91 offen offset:0 sc1
    s_waitcnt vmcnt(13)
    v_mfma_f32_32x32x16_bf16 v[64:79], v[120:123], v[236:239], v[64:79]
    ds_read_b64_tr_b16 v[104:105], v26 offset:2048
    ds_read_b64_tr_b16 v[106:107], v26 offset:2560
    ds_read_b64_tr_b16 v[108:109], v27 offset:2048
    ds_read_b64_tr_b16 v[110:111], v27 offset:2560
    v_mfma_f32_32x32x16_bf16 v[80:95], v[124:127], v[236:239], v[80:95]
    buffer_load_dwordx4 v[180:183], v248, s[60:63], s91 offen offset:1024 sc1
    s_waitcnt vmcnt(13)
    s_waitcnt lgkmcnt(4)
    v_mfma_f32_32x32x16_bf16 v[64:79], v[96:99], v[128:131], v[64:79]
    ds_read_b64_tr_b16 v[112:113], v26 offset:4096
    ds_read_b64_tr_b16 v[114:115], v26 offset:4608
    ds_read_b64_tr_b16 v[116:117], v27 offset:4096
    ds_read_b64_tr_b16 v[118:119], v27 offset:4608
    v_mfma_f32_32x32x16_bf16 v[80:95], v[100:103], v[128:131], v[80:95]
    buffer_load_dwordx4 v[184:187], v248, s[60:63], s91 offen offset:2048 sc1
    s_waitcnt vmcnt(13)
    s_waitcnt lgkmcnt(4)
    v_mfma_f32_32x32x16_bf16 v[64:79], v[104:107], v[132:135], v[64:79]
    ds_read_b64_tr_b16 v[120:121], v26 offset:6144
    ds_read_b64_tr_b16 v[122:123], v26 offset:6656
    ds_read_b64_tr_b16 v[124:125], v27 offset:6144
    ds_read_b64_tr_b16 v[126:127], v27 offset:6656
    v_mfma_f32_32x32x16_bf16 v[80:95], v[108:111], v[132:135], v[80:95]
    buffer_load_dwordx4 v[188:191], v248, s[60:63], s91 offen offset:3072 sc1
    s_waitcnt vmcnt(13)
    s_waitcnt lgkmcnt(4)
    v_mfma_f32_32x32x16_bf16 v[64:79], v[112:115], v[136:139], v[64:79]
    ds_read_b64_tr_b16 v[96:97], v26 offset:16384
    ds_read_b64_tr_b16 v[98:99], v26 offset:16896
    ds_read_b64_tr_b16 v[100:101], v27 offset:16384
    ds_read_b64_tr_b16 v[102:103], v27 offset:16896
    v_mfma_f32_32x32x16_bf16 v[80:95], v[116:119], v[136:139], v[80:95]
    s_lshl_b32 s91, s84, 14
    s_add_u32 s91, s91, s97
    buffer_load_dwordx4 v[192:195], v248, s[60:63], s91 offen offset:0 sc1
    s_waitcnt vmcnt(13)
    s_waitcnt lgkmcnt(4)
    v_mfma_f32_32x32x16_bf16 v[64:79], v[120:123], v[140:143], v[64:79]
    ds_read_b64_tr_b16 v[104:105], v26 offset:18432
    ds_read_b64_tr_b16 v[106:107], v26 offset:18944
    ds_read_b64_tr_b16 v[108:109], v27 offset:18432
    ds_read_b64_tr_b16 v[110:111], v27 offset:18944
    v_mfma_f32_32x32x16_bf16 v[80:95], v[124:127], v[140:143], v[80:95]
    buffer_load_dwordx4 v[196:199], v248, s[60:63], s91 offen offset:1024 sc1
    s_waitcnt vmcnt(13)
    s_waitcnt lgkmcnt(4)
    v_mfma_f32_32x32x16_bf16 v[64:79], v[96:99], v[144:147], v[64:79]
    ds_read_b64_tr_b16 v[112:113], v26 offset:20480
    ds_read_b64_tr_b16 v[114:115], v26 offset:20992
    ds_read_b64_tr_b16 v[116:117], v27 offset:20480
    ds_read_b64_tr_b16 v[118:119], v27 offset:20992
    v_mfma_f32_32x32x16_bf16 v[80:95], v[100:103], v[144:147], v[80:95]
    buffer_load_dwordx4 v[200:203], v248, s[60:63], s91 offen offset:2048 sc1
    s_waitcnt vmcnt(13)
    s_waitcnt lgkmcnt(4)
    v_mfma_f32_32x32x16_bf16 v[64:79], v[104:107], v[148:151], v[64:79]
    ds_read_b64_tr_b16 v[120:121], v26 offset:22528
    ds_read_b64_tr_b16 v[122:123], v26 offset:23040
    ds_read_b64_tr_b16 v[124:125], v27 offset:22528
    ds_read_b64_tr_b16 v[126:127], v27 offset:23040
    v_mfma_f32_32x32x16_bf16 v[80:95], v[108:111], v[148:151], v[80:95]
    buffer_load_dwordx4 v[204:207], v248, s[60:63], s91 offen offset:3072 sc1
    s_waitcnt vmcnt(13)
    s_waitcnt lgkmcnt(4)
    v_mfma_f32_32x32x16_bf16 v[64:79], v[112:115], v[152:155], v[64:79]
    ds_read_b64_tr_b16 v[96:97], v26 offset:32768
    ds_read_b64_tr_b16 v[98:99], v26 offset:33280
    ds_read_b64_tr_b16 v[100:101], v27 offset:32768
    ds_read_b64_tr_b16 v[102:103], v27 offset:33280
    v_mfma_f32_32x32x16_bf16 v[80:95], v[116:119], v[152:155], v[80:95]
    s_lshl_b32 s91, s85, 14
    s_add_u32 s91, s91, s97
    buffer_load_dwordx4 v[208:211], v248, s[60:63], s91 offen offset:0 sc1
    s_waitcnt vmcnt(13)
    s_waitcnt lgkmcnt(4)
    v_mfma_f32_32x32x16_bf16 v[64:79], v[120:123], v[156:159], v[64:79]
    ds_read_b64_tr_b16 v[104:105], v26 offset:34816
    ds_read_b64_tr_b16 v[106:107], v26 offset:35328
    ds_read_b64_tr_b16 v[108:109], v27 offset:34816
    ds_read_b64_tr_b16 v[110:111], v27 offset:35328
    v_mfma_f32_32x32x16_bf16 v[80:95], v[124:127], v[156:159], v[80:95]
    buffer_load_dwordx4 v[212:215], v248, s[60:63], s91 offen offset:1024 sc1
    s_waitcnt vmcnt(13)
    s_waitcnt lgkmcnt(4)
    v_mfma_f32_32x32x16_bf16 v[64:79], v[96:99], v[160:163], v[64:79]
    ds_read_b64_tr_b16 v[112:113], v26 offset:36864
    ds_read_b64_tr_b16 v[114:115], v26 offset:37376
    ds_read_b64_tr_b16 v[116:117], v27 offset:36864
    ds_read_b64_tr_b16 v[118:119], v27 offset:37376
    v_mfma_f32_32x32x16_bf16 v[80:95], v[100:103], v[160:163], v[80:95]
    buffer_load_dwordx4 v[216:219], v248, s[60:63], s91 offen offset:2048 sc1
    s_waitcnt vmcnt(13)
    s_waitcnt lgkmcnt(4)
    v_mfma_f32_32x32x16_bf16 v[64:79], v[104:107], v[164:167], v[64:79]
    ds_read_b64_tr_b16 v[120:121], v26 offset:38912
    ds_read_b64_tr_b16 v[122:123], v26 offset:39424
    ds_read_b64_tr_b16 v[124:125], v27 offset:38912
    ds_read_b64_tr_b16 v[126:127], v27 offset:39424
    v_mfma_f32_32x32x16_bf16 v[80:95], v[108:111], v[164:167], v[80:95]
    buffer_load_dwordx4 v[220:223], v248, s[60:63], s91 offen offset:3072 sc1
    s_waitcnt vmcnt(13)
    s_waitcnt lgkmcnt(0)
    v_mfma_f32_32x32x16_bf16 v[64:79], v[112:115], v[168:171], v[64:79]
    s_barrier
    ds_read_b64_tr_b16 v[96:97], v28 offset:0
    ds_read_b64_tr_b16 v[98:99], v28 offset:512
    ds_read_b64_tr_b16 v[100:101], v29 offset:0
    ds_read_b64_tr_b16 v[102:103], v29 offset:512
    v_mfma_f32_32x32x16_bf16 v[80:95], v[116:119], v[168:171], v[80:95]
    s_lshl_b32 s91, s86, 14
    s_add_u32 s91, s91, s97
    buffer_load_dwordx4 v[224:227], v248, s[60:63], s91 offen offset:0 sc1
    s_waitcnt vmcnt(13)
    v_mfma_f32_32x32x16_bf16 v[64:79], v[120:123], v[172:175], v[64:79]
    ds_read_b64_tr_b16 v[104:105], v28 offset:2048
    ds_read_b64_tr_b16 v[106:107], v28 offset:2560
    ds_read_b64_tr_b16 v[108:109], v29 offset:2048
    ds_read_b64_tr_b16 v[110:111], v29 offset:2560
    v_mfma_f32_32x32x16_bf16 v[80:95], v[124:127], v[172:175], v[80:95]
    buffer_load_dwordx4 v[228:231], v248, s[60:63], s91 offen offset:1024 sc1
    s_waitcnt vmcnt(13)
    s_waitcnt lgkmcnt(4)
    v_mfma_f32_32x32x16_bf16 v[64:79], v[96:99], v[176:179], v[64:79]
    ds_read_b64_tr_b16 v[112:113], v28 offset:4096
    ds_read_b64_tr_b16 v[114:115], v28 offset:4608
    ds_read_b64_tr_b16 v[116:117], v29 offset:4096
    ds_read_b64_tr_b16 v[118:119], v29 offset:4608
    v_mfma_f32_32x32x16_bf16 v[80:95], v[100:103], v[176:179], v[80:95]
    buffer_load_dwordx4 v[232:235], v248, s[60:63], s91 offen offset:2048 sc1
    s_waitcnt vmcnt(13)
    s_waitcnt lgkmcnt(4)
    v_mfma_f32_32x32x16_bf16 v[64:79], v[104:107], v[180:183], v[64:79]
    ds_read_b64_tr_b16 v[120:121], v28 offset:6144
    ds_read_b64_tr_b16 v[122:123], v28 offset:6656
    ds_read_b64_tr_b16 v[124:125], v29 offset:6144
    ds_read_b64_tr_b16 v[126:127], v29 offset:6656
    v_mfma_f32_32x32x16_bf16 v[80:95], v[108:111], v[180:183], v[80:95]
    buffer_load_dwordx4 v[236:239], v248, s[60:63], s91 offen offset:3072 sc1
    s_waitcnt vmcnt(13)
    s_waitcnt lgkmcnt(4)
    v_mfma_f32_32x32x16_bf16 v[64:79], v[112:115], v[184:187], v[64:79]
    ds_read_b64_tr_b16 v[96:97], v28 offset:16384
    ds_read_b64_tr_b16 v[98:99], v28 offset:16896
    v_mfma_f32_32x32x16_bf16 v[80:95], v[116:119], v[184:187], v[80:95]
    ds_read_b64_tr_b16 v[100:101], v29 offset:16384
    ds_read_b64_tr_b16 v[102:103], v29 offset:16896
    s_waitcnt vmcnt(12)
    s_waitcnt lgkmcnt(4)
    v_mfma_f32_32x32x16_bf16 v[64:79], v[120:123], v[188:191], v[64:79]
    ds_read_b64_tr_b16 v[104:105], v28 offset:18432
    ds_read_b64_tr_b16 v[106:107], v28 offset:18944
    v_mfma_f32_32x32x16_bf16 v[80:95], v[124:127], v[188:191], v[80:95]
    ds_read_b64_tr_b16 v[108:109], v29 offset:18432
    ds_read_b64_tr_b16 v[110:111], v29 offset:18944
    s_waitcnt vmcnt(11)
    s_waitcnt lgkmcnt(4)
    v_mfma_f32_32x32x16_bf16 v[64:79], v[96:99], v[192:195], v[64:79]
    ds_read_b64_tr_b16 v[112:113], v28 offset:20480
    ds_read_b64_tr_b16 v[114:115], v28 offset:20992
    v_mfma_f32_32x32x16_bf16 v[80:95], v[100:103], v[192:195], v[80:95]
    ds_read_b64_tr_b16 v[116:117], v29 offset:20480
    ds_read_b64_tr_b16 v[118:119], v29 offset:20992
    s_waitcnt vmcnt(10)
    s_waitcnt lgkmcnt(4)
    v_mfma_f32_32x32x16_bf16 v[64:79], v[104:107], v[196:199], v[64:79]
    ds_read_b64_tr_b16 v[120:121], v28 offset:22528
    ds_read_b64_tr_b16 v[122:123], v28 offset:23040
    v_mfma_f32_32x32x16_bf16 v[80:95], v[108:111], v[196:199], v[80:95]
    ds_read_b64_tr_b16 v[124:125], v29 offset:22528
    ds_read_b64_tr_b16 v[126:127], v29 offset:23040
    s_waitcnt vmcnt(9)
    s_waitcnt lgkmcnt(4)
    v_mfma_f32_32x32x16_bf16 v[64:79], v[112:115], v[200:203], v[64:79]
    ds_read_b64_tr_b16 v[96:97], v28 offset:32768
    ds_read_b64_tr_b16 v[98:99], v28 offset:33280
    v_mfma_f32_32x32x16_bf16 v[80:95], v[116:119], v[200:203], v[80:95]
    ds_read_b64_tr_b16 v[100:101], v29 offset:32768
    ds_read_b64_tr_b16 v[102:103], v29 offset:33280
    s_waitcnt vmcnt(8)
    s_waitcnt lgkmcnt(4)
    v_mfma_f32_32x32x16_bf16 v[64:79], v[120:123], v[204:207], v[64:79]
    ds_read_b64_tr_b16 v[104:105], v28 offset:34816
    ds_read_b64_tr_b16 v[106:107], v28 offset:35328
    v_mfma_f32_32x32x16_bf16 v[80:95], v[124:127], v[204:207], v[80:95]
    ds_read_b64_tr_b16 v[108:109], v29 offset:34816
    ds_read_b64_tr_b16 v[110:111], v29 offset:35328
    s_waitcnt vmcnt(7)
    s_waitcnt lgkmcnt(4)
    v_mfma_f32_32x32x16_bf16 v[64:79], v[96:99], v[208:211], v[64:79]
    ds_read_b64_tr_b16 v[112:113], v28 offset:36864
    ds_read_b64_tr_b16 v[114:115], v28 offset:37376
    v_mfma_f32_32x32x16_bf16 v[80:95], v[100:103], v[208:211], v[80:95]
    ds_read_b64_tr_b16 v[116:117], v29 offset:36864
    ds_read_b64_tr_b16 v[118:119], v29 offset:37376
    s_waitcnt vmcnt(6)
    s_waitcnt lgkmcnt(4)
    v_mfma_f32_32x32x16_bf16 v[64:79], v[104:107], v[212:215], v[64:79]
    ds_read_b64_tr_b16 v[120:121], v28 offset:38912
    ds_read_b64_tr_b16 v[122:123], v28 offset:39424
    v_mfma_f32_32x32x16_bf16 v[80:95], v[108:111], v[212:215], v[80:95]
    ds_read_b64_tr_b16 v[124:125], v29 offset:38912
    ds_read_b64_tr_b16 v[126:127], v29 offset:39424
    s_waitcnt vmcnt(5)
    s_waitcnt lgkmcnt(0)
    v_mfma_f32_32x32x16_bf16 v[64:79], v[112:115], v[216:219], v[64:79]
    s_barrier
    ds_read_b64_tr_b16 v[96:97], v28 offset:49152
    ds_read_b64_tr_b16 v[98:99], v28 offset:49664
    v_mfma_f32_32x32x16_bf16 v[80:95], v[116:119], v[216:219], v[80:95]
    ds_read_b64_tr_b16 v[100:101], v29 offset:49152
    ds_read_b64_tr_b16 v[102:103], v29 offset:49664
    s_waitcnt vmcnt(4)
    v_mfma_f32_32x32x16_bf16 v[64:79], v[120:123], v[220:223], v[64:79]
    ds_read_b64_tr_b16 v[104:105], v28 offset:51200
    ds_read_b64_tr_b16 v[106:107], v28 offset:51712
    v_mfma_f32_32x32x16_bf16 v[80:95], v[124:127], v[220:223], v[80:95]
    ds_read_b64_tr_b16 v[108:109], v29 offset:51200
    ds_read_b64_tr_b16 v[110:111], v29 offset:51712
    s_waitcnt vmcnt(3)
    s_waitcnt lgkmcnt(4)
    v_mfma_f32_32x32x16_bf16 v[64:79], v[96:99], v[224:227], v[64:79]
    ds_read_b64_tr_b16 v[112:113], v28 offset:53248
    ds_read_b64_tr_b16 v[114:115], v28 offset:53760
    ds_read_b64_tr_b16 v[116:117], v29 offset:53248
    ds_read_b64_tr_b16 v[118:119], v29 offset:53760
    s_waitcnt vmcnt(2)
    s_waitcnt lgkmcnt(4)
    v_mfma_f32_32x32x16_bf16 v[64:79], v[104:107], v[228:231], v[64:79]
    ds_read_b64_tr_b16 v[120:121], v28 offset:55296
    ds_read_b64_tr_b16 v[122:123], v28 offset:55808
    ds_read_b64_tr_b16 v[124:125], v29 offset:55296
    ds_read_b64_tr_b16 v[126:127], v29 offset:55808
    s_waitcnt vmcnt(1)
    s_waitcnt lgkmcnt(4)
    v_mfma_f32_32x32x16_bf16 v[64:79], v[112:115], v[232:235], v[64:79]
    s_waitcnt vmcnt(0)
    s_waitcnt lgkmcnt(0)
    v_mfma_f32_32x32x16_bf16 v[64:79], v[120:123], v[236:239], v[64:79]
    v_mfma_f32_32x32x16_bf16 v[80:95], v[100:103], v[224:227], v[80:95]
    v_mfma_f32_32x32x16_bf16 v[80:95], v[108:111], v[228:231], v[80:95]
    s_nop 9
    ds_write_b128 v4, v[64:67] offset:0
    v_mfma_f32_32x32x16_bf16 v[80:95], v[116:119], v[232:235], v[80:95]
    ds_write_b128 v4, v[68:71] offset:32
    v_mfma_f32_32x32x16_bf16 v[80:95], v[124:127], v[236:239], v[80:95]
    ds_write_b128 v4, v[72:75] offset:64
    ds_write_b128 v4, v[76:79] offset:96
    s_nop 9
    ds_write_b128 v4, v[80:83] offset:128
    ds_write_b128 v4, v[84:87] offset:160
    ds_write_b128 v4, v[88:91] offset:192
    ds_write_b128 v4, v[92:95] offset:224
    s_waitcnt lgkmcnt(0)
    s_barrier
    s_endpgm
L_HELPER:
    s_sub_u32 s76, s72, 28
    s_lshl_b32 s73, s71, 2
    s_add_u32 s73, s73, s76
    v_lshrrev_b32 v2, 3, v1
    v_and_b32 v3, 7, v1
    s_lshl_b32 s88, s73, 6
    s_lshl_b32 s89, s69, 3
    s_add_u32 s88, s88, s89
    v_add_u32 v6, s88, v2
    v_mul_u32_u24 v4, 896, v6
    v_lshl_add_u32 v4, v3, 4, v4
    s_waitcnt lgkmcnt(0)
    s_load_dword s68, s[46:47], 0
    s_mov_b64 s[48:49], s[16:17]
    s_mov_b64 s[60:61], s[46:47]
    s_mov_b64 s[56:57], s[40:41]
    s_mov_b64 s[64:65], s[42:43]
    buffer_load_dwordx4 v[8:11], v4, s[48:51], 0 offen offset:0
    buffer_load_dwordx4 v[12:15], v4, s[48:51], 0 offen offset:128
    buffer_load_dwordx4 v[16:19], v4, s[48:51], 0 offen offset:256
    buffer_load_dwordx4 v[20:23], v4, s[48:51], 0 offen offset:384
    buffer_load_dwordx4 v[24:27], v4, s[48:51], 0 offen offset:512
    buffer_load_dwordx4 v[28:31], v4, s[48:51], 0 offen offset:640
    buffer_load_dwordx4 v[32:35], v4, s[48:51], 0 offen offset:768
    s_lshr_b32 s89, s71, 1
    s_lshl_b32 s89, s89, 2
    s_add_u32 s89, s89, s76
    s_min_u32 s89, s89, 13
    s_cmp_ge_u32 s89, 7
    s_cselect_b32 s52, s38, s36
    s_cselect_b32 s53, s39, s37
    s_cselect_b32 s90, 7, 0
    s_and_b32 s91, s71, 1
    s_mul_i32 s91, s91, 7
    s_add_u32 s89, s89, s91
    s_add_u32 s74, s89, s90
    s_sub_u32 s89, s89, s90
    s_lshl_b32 s89, s89, 8
    s_mul_i32 s90, s69, 200704
    s_add_u32 s89, s89, s90
    v_mul_u32_u24 v5, 3584, v2
    v_lshl_add_u32 v5, v3, 4, v5
    v_add_u32 v5, s89, v5
    v_min_u32 v7, 13, v1
    v_mul_u32_u24 v7, 4224, v7
    v_mov_b32 v178, 0
    s_mul_i32 s90, s73, 59136
    s_add_u32 s90, s90, 131196
    s_cmp_lg_u32 s69, 7
    s_cbranch_scc1 L_NOZ
    s_mov_b64 exec, 0x3fff
    buffer_store_dword v178, v7, s[60:63], s90 offen sc1
    s_mov_b64 exec, -1
L_NOZ:
    s_waitcnt lgkmcnt(0)
    s_mul_i32 s68, s68, 0x19660d
    s_add_u32 s68, s68, 0x3c6ef35f
    v_mov_b32 v160, 0x3f803f80
    v_mov_b32 v148, 0
    v_mov_b32 v149, 0
    s_waitcnt vmcnt(0)
    s_mov_b32 s78, 0
    buffer_load_dwordx4 v[36:39], v5, s[52:55], s78 offen offset:0
    v_dot2_f32_bf16 v148, v8, v160, v148
    v_dot2_f32_bf16 v149, v8, v8, v149
    v_dot2_f32_bf16 v148, v9, v160, v148
    v_dot2_f32_bf16 v149, v9, v9, v149
    v_dot2_f32_bf16 v148, v10, v160, v148
    v_dot2_f32_bf16 v149, v10, v10, v149
    v_dot2_f32_bf16 v148, v11, v160, v148
    v_dot2_f32_bf16 v149, v11, v11, v149
    v_dot2_f32_bf16 v148, v12, v160, v148
    v_dot2_f32_bf16 v149, v12, v12, v149
    v_dot2_f32_bf16 v148, v13, v160, v148
    v_dot2_f32_bf16 v149, v13, v13, v149
    v_dot2_f32_bf16 v148, v14, v160, v148
    v_dot2_f32_bf16 v149, v14, v14, v149
    v_dot2_f32_bf16 v148, v15, v160, v148
    s_mov_b32 s78, 28672
    buffer_load_dwordx4 v[40:43], v5, s[52:55], s78 offen offset:0
    v_dot2_f32_bf16 v149, v15, v15, v149
    v_dot2_f32_bf16 v148, v16, v160, v148
    v_dot2_f32_bf16 v149, v16, v16, v149
    v_dot2_f32_bf16 v148, v17, v160, v148
    v_dot2_f32_bf16 v149, v17, v17, v149
    v_dot2_f32_bf16 v148, v18, v160, v148
    v_dot2_f32_bf16 v149, v18, v18, v149
    v_dot2_f32_bf16 v148, v19, v160, v148
    v_dot2_f32_bf16 v149, v19, v19, v149
    v_dot2_f32_bf16 v148, v20, v160, v148
    v_dot2_f32_bf16 v149, v20, v20, v149
    v_dot2_f32_bf16 v148, v21, v160, v148
    v_dot2_f32_bf16 v149, v21, v21, v149
    v_dot2_f32_bf16 v148, v22, v160, v148
    s_mov_b32 s78, 57344
    buffer_load_dwordx4 v[44:47], v5, s[52:55], s78 offen offset:0
    v_dot2_f32_bf16 v149, v22, v22, v149
    v_dot2_f32_bf16 v148, v23, v160, v148
    v_dot2_f32_bf16 v149, v23, v23, v149
    v_dot2_f32_bf16 v148, v24, v160, v148
    v_dot2_f32_bf16 v149, v24, v24, v149
    v_dot2_f32_bf16 v148, v25, v160, v148
    v_dot2_f32_bf16 v149, v25, v25, v149
    v_dot2_f32_bf16 v148, v26, v160, v148
    v_dot2_f32_bf16 v149, v26, v26, v149
    v_dot2_f32_bf16 v148, v27, v160, v148
    v_dot2_f32_bf16 v149, v27, v27, v149
    v_dot2_f32_bf16 v148, v28, v160, v148
    v_dot2_f32_bf16 v149, v28, v28, v149
    v_dot2_f32_bf16 v148, v29, v160, v148
    s_mov_b32 s78, 86016
    buffer_load_dwordx4 v[48:51], v5, s[52:55], s78 offen offset:0
    v_dot2_f32_bf16 v149, v29, v29, v149
    v_dot2_f32_bf16 v148, v30, v160, v148
    v_dot2_f32_bf16 v149, v30, v30, v149
    v_dot2_f32_bf16 v148, v31, v160, v148
    v_dot2_f32_bf16 v149, v31, v31, v149
    v_dot2_f32_bf16 v148, v32, v160, v148
    v_dot2_f32_bf16 v149, v32, v32, v149
    v_dot2_f32_bf16 v148, v33, v160, v148
    v_dot2_f32_bf16 v149, v33, v33, v149
    v_dot2_f32_bf16 v148, v34, v160, v148
    v_dot2_f32_bf16 v149, v34, v34, v149
    v_dot2_f32_bf16 v148, v35, v160, v148
    v_dot2_f32_bf16 v149, v35, v35, v149
    s_nop 1
    v_add_f32_dpp v148, v148, v148 quad_perm:[1,0,3,2] row_mask:0xf bank_mask:0xf
    s_nop 1
    v_add_f32_dpp v148, v148, v148 quad_perm:[2,3,0,1] row_mask:0xf bank_mask:0xf
    s_nop 1
    v_add_f32_dpp v148, v148, v148 row_half_mirror row_mask:0xf bank_mask:0xf
    v_add_f32_dpp v149, v149, v149 quad_perm:[1,0,3,2] row_mask:0xf bank_mask:0xf
    s_nop 1
    v_add_f32_dpp v149, v149, v149 quad_perm:[2,3,0,1] row_mask:0xf bank_mask:0xf
    s_nop 1
    v_add_f32_dpp v149, v149, v149 row_half_mirror row_mask:0xf bank_mask:0xf
    s_mov_b32 s91, 0x3b124925
    v_mul_f32 v152, s91, v148
    v_cvt_pk_bf16_f32 v150, v152, v152
    v_mul_f32 v152, v152, v152
    v_lshlrev_b32 v150, 16, v150
    v_fma_f32 v148, v149, s91, -v152
    v_max_f32 v148, 0, v148
    v_cvt_pk_bf16_f32 v148, v148, v148
    v_lshlrev_b32 v148, 16, v148
    v_add_f32 v148, 0x3727c5ac, v148
    v_cvt_pk_bf16_f32 v148, v148, v148
    v_lshlrev_b32 v148, 16, v148
    v_sqrt_f32 v148, v148
    s_nop 0
    v_cvt_pk_bf16_f32 v156, v150, v148
    v_mov_b32 v157, s68
    v_and_b32 v154, 0xffff0000, v156
    v_rcp_f32 v154, v154
    v_lshlrev_b32 v158, 3, v6
    s_mov_b32 s90, 32768
    s_mov_b32 exec_lo, 0x01010101
    s_mov_b32 exec_hi, 0x01010101
    buffer_store_dwordx2 v[156:157], v158, s[60:63], s90 offen sc1
    s_mov_b64 exec, -1
    s_cmp_lg_u32 s69, 0
    s_cbranch_scc1 L_NOF
    v_lshlrev_b32 v7, 7, v1
    s_mul_i32 s90, s73, 2304
    s_add_u32 s90, s90, 4096
    s_mov_b64 exec, 0x3ffff
    buffer_load_dword v179, v7, s[60:63], s90 offen sc1
    s_mov_b64 exec, -1
    v_add_u32 v7, 0, v1
    v_min_u32 v7, 41, v7
    v_lshlrev_b32 v7, 7, v7
    s_mul_i32 s90, s73, 5376
    s_add_u32 s90, s90, 3932160
    buffer_load_dword v179, v7, s[60:63], s90 offen sc1
L_NOF:
    s_lshl_b32 s89, s69, 3
    v_add_u32 v170, s89, v2
    v_mul_u32_u24 v170, 272, v170
    v_lshl_add_u32 v170, v3, 5, v170
    v_add_u32 v170, 61440, v170
    v_add_u32 v172, s89, v2
    v_mul_u32_u24 v171, 272, v3
    v_lshl_add_u32 v171, v172, 2, v171
    v_add_u32 v171, 61440, v171
    v_lshlrev_b32 v172, 3, v172
    s_mov_b32 s78, 114688
    buffer_load_dwordx4 v[52:55], v5, s[52:55], s78 offen offset:0
    v_mul_f32 v152, v150, v154
    v_lshlrev_b32 v92, 16, v8
    v_and_b32 v93, 0xffff0000, v8
    v_pk_fma_f32 v[92:93], v[92:93], v[154:155], v[152:153] op_sel_hi:[1,0,0] neg_lo:[0,0,1] neg_hi:[0,0,1]
    v_cvt_pk_bf16_f32 v8, v92, v93
    v_lshlrev_b32 v94, 16, v9
    v_and_b32 v95, 0xffff0000, v9
    v_pk_fma_f32 v[94:95], v[94:95], v[154:155], v[152:153] op_sel_hi:[1,0,0] neg_lo:[0,0,1] neg_hi:[0,0,1]
    v_cvt_pk_bf16_f32 v9, v94, v95
    v_lshlrev_b32 v96, 16, v10
    v_and_b32 v97, 0xffff0000, v10
    v_pk_fma_f32 v[96:97], v[96:97], v[154:155], v[152:153] op_sel_hi:[1,0,0] neg_lo:[0,0,1] neg_hi:[0,0,1]
    s_mov_b32 s78, 143360
    buffer_load_dwordx4 v[56:59], v5, s[52:55], s78 offen offset:0
    v_cvt_pk_bf16_f32 v10, v96, v97
    v_lshlrev_b32 v98, 16, v11
    v_and_b32 v99, 0xffff0000, v11
    v_pk_fma_f32 v[98:99], v[98:99], v[154:155], v[152:153] op_sel_hi:[1,0,0] neg_lo:[0,0,1] neg_hi:[0,0,1]
    v_cvt_pk_bf16_f32 v11, v98, v99
    v_lshlrev_b32 v92, 16, v12
    v_and_b32 v93, 0xffff0000, v12
    v_pk_fma_f32 v[92:93], v[92:93], v[154:155], v[152:153] op_sel_hi:[1,0,0] neg_lo:[0,0,1] neg_hi:[0,0,1]
    v_cvt_pk_bf16_f32 v12, v92, v93
    v_lshlrev_b32 v94, 16, v13
    v_and_b32 v95, 0xffff0000, v13
    s_mov_b32 s78, 172032
    buffer_load_dwordx4 v[60:63], v5, s[52:55], s78 offen offset:0
    v_pk_fma_f32 v[94:95], v[94:95], v[154:155], v[152:153] op_sel_hi:[1,0,0] neg_lo:[0,0,1] neg_hi:[0,0,1]
    v_cvt_pk_bf16_f32 v13, v94, v95
    v_lshlrev_b32 v96, 16, v14
    v_and_b32 v97, 0xffff0000, v14
    v_pk_fma_f32 v[96:97], v[96:97], v[154:155], v[152:153] op_sel_hi:[1,0,0] neg_lo:[0,0,1] neg_hi:[0,0,1]
    v_cvt_pk_bf16_f32 v14, v96, v97
    v_lshlrev_b32 v98, 16, v15
    v_and_b32 v99, 0xffff0000, v15
    v_pk_fma_f32 v[98:99], v[98:99], v[154:155], v[152:153] op_sel_hi:[1,0,0] neg_lo:[0,0,1] neg_hi:[0,0,1]
    v_cvt_pk_bf16_f32 v15, v98, v99
    v_lshlrev_b32 v92, 16, v16
    v_and_b32 v93, 0xffff0000, v16
    v_pk_fma_f32 v[92:93], v[92:93], v[154:155], v[152:153] op_sel_hi:[1,0,0] neg_lo:[0,0,1] neg_hi:[0,0,1]
    v_cvt_pk_bf16_f32 v16, v92, v93
    v_lshlrev_b32 v94, 16, v17
    v_and_b32 v95, 0xffff0000, v17
    v_pk_fma_f32 v[94:95], v[94:95], v[154:155], v[152:153] op_sel_hi:[1,0,0] neg_lo:[0,0,1] neg_hi:[0,0,1]
    v_cvt_pk_bf16_f32 v17, v94, v95
    v_lshlrev_b32 v96, 16, v18
    v_and_b32 v97, 0xffff0000, v18
    v_pk_fma_f32 v[96:97], v[96:97], v[154:155], v[152:153] op_sel_hi:[1,0,0] neg_lo:[0,0,1] neg_hi:[0,0,1]
    v_cvt_pk_bf16_f32 v18, v96, v97
    v_lshlrev_b32 v98, 16, v19
    v_and_b32 v99, 0xffff0000, v19
    v_pk_fma_f32 v[98:99], v[98:99], v[154:155], v[152:153] op_sel_hi:[1,0,0] neg_lo:[0,0,1] neg_hi:[0,0,1]
    v_cvt_pk_bf16_f32 v19, v98, v99
    v_lshlrev_b32 v92, 16, v20
    v_and_b32 v93, 0xffff0000, v20
    v_pk_fma_f32 v[92:93], v[92:93], v[154:155], v[152:153] op_sel_hi:[1,0,0] neg_lo:[0,0,1] neg_hi:[0,0,1]
    v_cvt_pk_bf16_f32 v20, v92, v93
    v_lshlrev_b32 v94, 16, v21
    v_and_b32 v95, 0xffff0000, v21
    v_pk_fma_f32 v[94:95], v[94:95], v[154:155], v[152:153] op_sel_hi:[1,0,0] neg_lo:[0,0,1] neg_hi:[0,0,1]
    v_cvt_pk_bf16_f32 v21, v94, v95
    v_lshlrev_b32 v96, 16, v22
    v_and_b32 v97, 0xffff0000, v22
    v_pk_fma_f32 v[96:97], v[96:97], v[154:155], v[152:153] op_sel_hi:[1,0,0] neg_lo:[0,0,1] neg_hi:[0,0,1]
    v_cvt_pk_bf16_f32 v22, v96, v97
    v_lshlrev_b32 v98, 16, v23
    v_and_b32 v99, 0xffff0000, v23
    v_pk_fma_f32 v[98:99], v[98:99], v[154:155], v[152:153] op_sel_hi:[1,0,0] neg_lo:[0,0,1] neg_hi:[0,0,1]
    v_cvt_pk_bf16_f32 v23, v98, v99
    v_lshlrev_b32 v92, 16, v24
    v_and_b32 v93, 0xffff0000, v24
    v_pk_fma_f32 v[92:93], v[92:93], v[154:155], v[152:153] op_sel_hi:[1,0,0] neg_lo:[0,0,1] neg_hi:[0,0,1]
    v_cvt_pk_bf16_f32 v24, v92, v93
    v_lshlrev_b32 v94, 16, v25
    v_and_b32 v95, 0xffff0000, v25
    v_pk_fma_f32 v[94:95], v[94:95], v[154:155], v[152:153] op_sel_hi:[1,0,0] neg_lo:[0,0,1] neg_hi:[0,0,1]
    v_cvt_pk_bf16_f32 v25, v94, v95
    v_lshlrev_b32 v96, 16, v26
    v_and_b32 v97, 0xffff0000, v26
    v_pk_fma_f32 v[96:97], v[96:97], v[154:155], v[152:153] op_sel_hi:[1,0,0] neg_lo:[0,0,1] neg_hi:[0,0,1]
    v_cvt_pk_bf16_f32 v26, v96, v97
    v_lshlrev_b32 v98, 16, v27
    v_and_b32 v99, 0xffff0000, v27
    v_pk_fma_f32 v[98:99], v[98:99], v[154:155], v[152:153] op_sel_hi:[1,0,0] neg_lo:[0,0,1] neg_hi:[0,0,1]
    v_cvt_pk_bf16_f32 v27, v98, v99
    v_lshlrev_b32 v92, 16, v28
    v_and_b32 v93, 0xffff0000, v28
    v_pk_fma_f32 v[92:93], v[92:93], v[154:155], v[152:153] op_sel_hi:[1,0,0] neg_lo:[0,0,1] neg_hi:[0,0,1]
    v_cvt_pk_bf16_f32 v28, v92, v93
    v_lshlrev_b32 v94, 16, v29
    v_and_b32 v95, 0xffff0000, v29
    v_pk_fma_f32 v[94:95], v[94:95], v[154:155], v[152:153] op_sel_hi:[1,0,0] neg_lo:[0,0,1] neg_hi:[0,0,1]
    v_cvt_pk_bf16_f32 v29, v94, v95
    v_lshlrev_b32 v96, 16, v30
    v_and_b32 v97, 0xffff0000, v30
    v_pk_fma_f32 v[96:97], v[96:97], v[154:155], v[152:153] op_sel_hi:[1,0,0] neg_lo:[0,0,1] neg_hi:[0,0,1]
    v_cvt_pk_bf16_f32 v30, v96, v97
    v_lshlrev_b32 v98, 16, v31
    v_and_b32 v99, 0xffff0000, v31
    v_pk_fma_f32 v[98:99], v[98:99], v[154:155], v[152:153] op_sel_hi:[1,0,0] neg_lo:[0,0,1] neg_hi:[0,0,1]
    v_cvt_pk_bf16_f32 v31, v98, v99
    v_lshlrev_b32 v92, 16, v32
    v_and_b32 v93, 0xffff0000, v32
    v_pk_fma_f32 v[92:93], v[92:93], v[154:155], v[152:153] op_sel_hi:[1,0,0] neg_lo:[0,0,1] neg_hi:[0,0,1]
    v_cvt_pk_bf16_f32 v32, v92, v93
    v_lshlrev_b32 v94, 16, v33
    v_and_b32 v95, 0xffff0000, v33
    v_pk_fma_f32 v[94:95], v[94:95], v[154:155], v[152:153] op_sel_hi:[1,0,0] neg_lo:[0,0,1] neg_hi:[0,0,1]
    v_cvt_pk_bf16_f32 v33, v94, v95
    v_lshlrev_b32 v96, 16, v34
    v_and_b32 v97, 0xffff0000, v34
    v_pk_fma_f32 v[96:97], v[96:97], v[154:155], v[152:153] op_sel_hi:[1,0,0] neg_lo:[0,0,1] neg_hi:[0,0,1]
    v_cvt_pk_bf16_f32 v34, v96, v97
    v_lshlrev_b32 v98, 16, v35
    v_and_b32 v99, 0xffff0000, v35
    v_pk_fma_f32 v[98:99], v[98:99], v[154:155], v[152:153] op_sel_hi:[1,0,0] neg_lo:[0,0,1] neg_hi:[0,0,1]
    v_cvt_pk_bf16_f32 v35, v98, v99
    v_add_u32 v173, s89, v2
    v_mul_u32_u24 v173, 928, v173
    s_lshr_b32 s90, s69, 2
    s_lshl_b32 s90, s90, 7
    v_lshl_add_u32 v173, v3, 4, v173
    v_add_u32 v173, s90, v173
    ds_write_b128 v173, v[8:11] offset:0
    ds_write_b128 v173, v[12:15] offset:128
    ds_write_b128 v173, v[16:19] offset:256
    ds_write_b128 v173, v[20:23] offset:384
    ds_write_b128 v173, v[24:27] offset:512
    ds_write_b128 v173, v[28:31] offset:640
    ds_write_b128 v173, v[32:35] offset:768
    s_waitcnt lgkmcnt(0)
    s_barrier
    v_and_b32 v174, 1, v1
    v_mul_u32_u24 v174, 29824, v174
    v_bfe_u32 v158, v1, 2, 2
    v_mul_u32_u24 v158, 928, v158
    v_add_u32 v174, v174, v158
    v_lshrrev_b32 v158, 4, v1
    v_lshl_add_u32 v174, v158, 4, v174
    v_bfe_u32 v158, v1, 1, 1
    v_lshl_add_u32 v174, v158, 3, v174
    s_lshl_b32 s90, s69, 7
    v_add_u32 v174, s90, v174
    v_mul_u32_u24 v175, 16896, v2
    v_lshl_add_u32 v175, v3, 4, v175
    s_mul_i32 s90, s69, 270336
    s_lshl_b32 s91, s73, 7
    s_add_u32 s90, s90, s91
    s_add_u32 s75, s90, 131200
    s_min_u32 s90, s69, 7
    s_lshl_b32 s90, s90, 13
    s_add_u32 s90, s90, 96256
    v_lshl_add_u32 v158, v2, 9, s90
    v_and_b32 v159, 3, v1
    v_lshl_add_u32 v180, v159, 7, v158
    v_lshl_add_u32 v180, v3, 4, v180
    v_lshl_add_u32 v184, v3, 4, v158
    v_xor_b32 v181, 16, v180
    v_xor_b32 v185, 144, v184
    v_xor_b32 v182, 32, v180
    v_xor_b32 v186, 288, v184
    v_xor_b32 v183, 48, v180
    v_xor_b32 v187, 432, v184
    s_cmp_eq_u32 s69, 7
    s_cselect_b32 s91, 0x40000000, 0
    v_or_b32 v175, s91, v175
    s_mov_b32 s78, 0
    buffer_load_dwordx4 v[64:67], v5, s[52:55], s78 offen offset:128
    ds_read_b64_tr_b16 v[92:93], v174 offset:0
    ds_read_b64_tr_b16 v[94:95], v174 offset:3712
    ds_read_b64_tr_b16 v[96:97], v174 offset:7424
    ds_read_b64_tr_b16 v[98:99], v174 offset:11136
    ds_read_b64_tr_b16 v[100:101], v174 offset:14848
    ds_read_b64_tr_b16 v[102:103], v174 offset:18560
    ds_read_b64_tr_b16 v[104:105], v174 offset:22272
    ds_read_b64_tr_b16 v[106:107], v174 offset:25984
    s_waitcnt lgkmcnt(0)
    s_mov_b32 s78, 28672
    buffer_load_dwordx4 v[68:71], v5, s[52:55], s78 offen offset:128
    ds_write_b128 v180, v[92:95] offset:0
    ds_write_b128 v181, v[96:99] offset:0
    s_mov_b32 s78, 57344
    buffer_load_dwordx4 v[72:75], v5, s[52:55], s78 offen offset:128
    ds_write_b128 v182, v[100:103] offset:0
    ds_write_b128 v183, v[104:107] offset:0
    ds_read_b128 v[124:127], v184 offset:0
    s_mov_b32 s78, 86016
    buffer_load_dwordx4 v[76:79], v5, s[52:55], s78 offen offset:128
    ds_read_b128 v[128:131], v185 offset:0
    ds_read_b128 v[132:135], v186 offset:0
    ds_read_b128 v[136:139], v187 offset:0
    s_waitcnt lgkmcnt(0)
    s_mov_b32 s78, 114688
    buffer_load_dwordx4 v[80:83], v5, s[52:55], s78 offen offset:128
    ds_read_b64_tr_b16 v[92:93], v174 offset:64
    ds_read_b64_tr_b16 v[94:95], v174 offset:3776
    ds_read_b64_tr_b16 v[96:97], v174 offset:7488
    ds_read_b64_tr_b16 v[98:99], v174 offset:11200
    ds_read_b64_tr_b16 v[100:101], v174 offset:14912
    ds_read_b64_tr_b16 v[102:103], v174 offset:18624
    ds_read_b64_tr_b16 v[104:105], v174 offset:22336
    ds_read_b64_tr_b16 v[106:107], v174 offset:26048
    s_waitcnt lgkmcnt(0)
    ds_write_b128 v180, v[92:95] offset:4096
    s_mov_b32 s78, 143360
    buffer_load_dwordx4 v[84:87], v5, s[52:55], s78 offen offset:128
    ds_write_b128 v181, v[96:99] offset:4096
    ds_write_b128 v182, v[100:103] offset:4096
    ds_write_b128 v183, v[104:107] offset:4096
    s_mov_b32 s78, 172032
    buffer_load_dwordx4 v[88:91], v5, s[52:55], s78 offen offset:128
    ds_read_b128 v[140:143], v184 offset:4096
    ds_read_b128 v[144:147], v185 offset:4096
    ds_read_b128 v[148:151], v186 offset:4096
    ds_read_b128 v[152:155], v187 offset:4096
    s_waitcnt lgkmcnt(0)
    s_add_u32 s77, s75, 0
    buffer_store_dwordx4 v[124:127], v175, s[60:63], s77 offen sc1
    s_waitcnt vmcnt(8)
    v_lshlrev_b32 v162, 16, v36
    v_and_b32 v163, 0xffff0000, v36
    v_lshlrev_b32 v164, 16, v37
    v_and_b32 v165, 0xffff0000, v37
    v_lshlrev_b32 v166, 16, v38
    v_and_b32 v167, 0xffff0000, v38
    v_lshlrev_b32 v168, 16, v39
    v_and_b32 v169, 0xffff0000, v39
    v_lshlrev_b32 v158, 16, v40
    v_and_b32 v159, 0xffff0000, v40
    v_pk_add_f32 v[162:163], v[162:163], v[158:159]
    v_lshlrev_b32 v158, 16, v41
    v_and_b32 v159, 0xffff0000, v41
    v_pk_add_f32 v[164:165], v[164:165], v[158:159]
    v_lshlrev_b32 v158, 16, v42
    v_and_b32 v159, 0xffff0000, v42
    v_pk_add_f32 v[166:167], v[166:167], v[158:159]
    v_lshlrev_b32 v158, 16, v43
    v_and_b32 v159, 0xffff0000, v43
    v_pk_add_f32 v[168:169], v[168:169], v[158:159]
    v_lshlrev_b32 v158, 16, v44
    v_and_b32 v159, 0xffff0000, v44
    v_pk_add_f32 v[162:163], v[162:163], v[158:159]
    v_lshlrev_b32 v158, 16, v45
    v_and_b32 v159, 0xffff0000, v45
    v_pk_add_f32 v[164:165], v[164:165], v[158:159]
    v_lshlrev_b32 v158, 16, v46
    v_and_b32 v159, 0xffff0000, v46
    v_pk_add_f32 v[166:167], v[166:167], v[158:159]
    v_lshlrev_b32 v158, 16, v47
    v_and_b32 v159, 0xffff0000, v47
    v_pk_add_f32 v[168:169], v[168:169], v[158:159]
    v_lshlrev_b32 v158, 16, v48
    v_and_b32 v159, 0xffff0000, v48
    v_pk_add_f32 v[162:163], v[162:163], v[158:159]
    v_lshlrev_b32 v158, 16, v49
    v_and_b32 v159, 0xffff0000, v49
    v_pk_add_f32 v[164:165], v[164:165], v[158:159]
    v_lshlrev_b32 v158, 16, v50
    v_and_b32 v159, 0xffff0000, v50
    v_pk_add_f32 v[166:167], v[166:167], v[158:159]
    v_lshlrev_b32 v158, 16, v51
    v_and_b32 v159, 0xffff0000, v51
    v_pk_add_f32 v[168:169], v[168:169], v[158:159]
    v_lshlrev_b32 v158, 16, v52
    v_and_b32 v159, 0xffff0000, v52
    v_pk_add_f32 v[162:163], v[162:163], v[158:159]
    v_lshlrev_b32 v158, 16, v53
    s_add_u32 s77, s75, 4224
    buffer_store_dwordx4 v[128:131], v175, s[60:63], s77 offen sc1
    v_and_b32 v159, 0xffff0000, v53
    v_pk_add_f32 v[164:165], v[164:165], v[158:159]
    v_lshlrev_b32 v158, 16, v54
    v_and_b32 v159, 0xffff0000, v54
    v_pk_add_f32 v[166:167], v[166:167], v[158:159]
    v_lshlrev_b32 v158, 16, v55
    v_and_b32 v159, 0xffff0000, v55
    v_pk_add_f32 v[168:169], v[168:169], v[158:159]
    v_lshlrev_b32 v158, 16, v56
    v_and_b32 v159, 0xffff0000, v56
    v_pk_add_f32 v[162:163], v[162:163], v[158:159]
    v_lshlrev_b32 v158, 16, v57
    v_and_b32 v159, 0xffff0000, v57
    v_pk_add_f32 v[164:165], v[164:165], v[158:159]
    v_lshlrev_b32 v158, 16, v58
    v_and_b32 v159, 0xffff0000, v58
    v_pk_add_f32 v[166:167], v[166:167], v[158:159]
    v_lshlrev_b32 v158, 16, v59
    v_and_b32 v159, 0xffff0000, v59
    v_pk_add_f32 v[168:169], v[168:169], v[158:159]
    v_lshlrev_b32 v158, 16, v60
    v_and_b32 v159, 0xffff0000, v60
    v_pk_add_f32 v[162:163], v[162:163], v[158:159]
    v_lshlrev_b32 v158, 16, v61
    v_and_b32 v159, 0xffff0000, v61
    v_pk_add_f32 v[164:165], v[164:165], v[158:159]
    v_lshlrev_b32 v158, 16, v62
    v_and_b32 v159, 0xffff0000, v62
    v_pk_add_f32 v[166:167], v[166:167], v[158:159]
    v_lshlrev_b32 v158, 16, v63
    v_and_b32 v159, 0xffff0000, v63
    v_pk_add_f32 v[168:169], v[168:169], v[158:159]
    ds_write_b128 v170, v[162:165] offset:0
    ds_write_b128 v170, v[166:169] offset:16
    s_waitcnt lgkmcnt(0)
    s_barrier
    ds_read_b32 v162, v171 offset:0
    ds_read_b32 v163, v171 offset:2176
    ds_read_b32 v164, v171 offset:4352
    ds_read_b32 v165, v171 offset:6528
    ds_read_b32 v166, v171 offset:8704
    ds_read_b32 v167, v171 offset:10880
    ds_read_b32 v168, v171 offset:13056
    ds_read_b32 v169, v171 offset:15232
    s_waitcnt lgkmcnt(0)
    v_add_f32 v162, v162, v163
    v_add_f32 v164, v164, v165
    v_add_f32 v166, v166, v167
    v_add_f32 v168, v168, v169
    v_add_f32 v162, v162, v164
    v_add_f32 v166, v166, v168
    v_add_f32 v162, v162, v166
    s_nop 1
    v_add_f32_dpp v162, v162, v162 quad_perm:[1,0,3,2] row_mask:0xf bank_mask:0xf
    s_nop 1
    v_add_f32_dpp v162, v162, v162 quad_perm:[2,3,0,1] row_mask:0xf bank_mask:0xf
    s_nop 1
    v_add_f32_dpp v162, v162, v162 row_half_mirror row_mask:0xf bank_mask:0xf
    v_mov_b32 v163, s68
    s_lshl_b32 s90, s74, 10
    s_add_u32 s90, s90, 49152
    s_mov_b32 exec_lo, 0x01010101
    s_mov_b32 exec_hi, 0x01010101
    buffer_store_dwordx2 v[162:163], v172, s[60:63], s90 offen sc1
    s_mov_b64 exec, -1
    s_add_u32 s77, s75, 8448
    buffer_store_dwordx4 v[132:135], v175, s[60:63], s77 offen sc1
    s_waitcnt vmcnt(4)
    v_lshlrev_b32 v162, 16, v64
    v_and_b32 v163, 0xffff0000, v64
    v_lshlrev_b32 v164, 16, v65
    v_and_b32 v165, 0xffff0000, v65
    v_lshlrev_b32 v166, 16, v66
    v_and_b32 v167, 0xffff0000, v66
    v_lshlrev_b32 v168, 16, v67
    v_and_b32 v169, 0xffff0000, v67
    v_lshlrev_b32 v158, 16, v68
    v_and_b32 v159, 0xffff0000, v68
    v_pk_add_f32 v[162:163], v[162:163], v[158:159]
    v_lshlrev_b32 v158, 16, v69
    v_and_b32 v159, 0xffff0000, v69
    v_pk_add_f32 v[164:165], v[164:165], v[158:159]
    v_lshlrev_b32 v158, 16, v70
    v_and_b32 v159, 0xffff0000, v70
    s_add_u32 s77, s75, 12672
    buffer_store_dwordx4 v[136:139], v175, s[60:63], s77 offen sc1
    v_pk_add_f32 v[166:167], v[166:167], v[158:159]
    v_lshlrev_b32 v158, 16, v71
    v_and_b32 v159, 0xffff0000, v71
    v_pk_add_f32 v[168:169], v[168:169], v[158:159]
    v_lshlrev_b32 v158, 16, v72
    v_and_b32 v159, 0xffff0000, v72
    v_pk_add_f32 v[162:163], v[162:163], v[158:159]
    v_lshlrev_b32 v158, 16, v73
    v_and_b32 v159, 0xffff0000, v73
    v_pk_add_f32 v[164:165], v[164:165], v[158:159]
    v_lshlrev_b32 v158, 16, v74
    v_and_b32 v159, 0xffff0000, v74
    v_pk_add_f32 v[166:167], v[166:167], v[158:159]
    v_lshlrev_b32 v158, 16, v75
    v_and_b32 v159, 0xffff0000, v75
    v_pk_add_f32 v[168:169], v[168:169], v[158:159]
    s_add_u32 s77, s75, 135168
    buffer_store_dwordx4 v[140:143], v175, s[60:63], s77 offen sc1
    v_lshlrev_b32 v158, 16, v76
    v_and_b32 v159, 0xffff0000, v76
    v_pk_add_f32 v[162:163], v[162:163], v[158:159]
    v_lshlrev_b32 v158, 16, v77
    v_and_b32 v159, 0xffff0000, v77
    v_pk_add_f32 v[164:165], v[164:165], v[158:159]
    v_lshlrev_b32 v158, 16, v78
    v_and_b32 v159, 0xffff0000, v78
    v_pk_add_f32 v[166:167], v[166:167], v[158:159]
    v_lshlrev_b32 v158, 16, v79
    v_and_b32 v159, 0xffff0000, v79
    v_pk_add_f32 v[168:169], v[168:169], v[158:159]
    v_lshlrev_b32 v158, 16, v80
    v_and_b32 v159, 0xffff0000, v80
    v_pk_add_f32 v[162:163], v[162:163], v[158:159]
    v_lshlrev_b32 v158, 16, v81
    s_add_u32 s77, s75, 139392
    buffer_store_dwordx4 v[144:147], v175, s[60:63], s77 offen sc1
    v_and_b32 v159, 0xffff0000, v81
    v_pk_add_f32 v[164:165], v[164:165], v[158:159]
    v_lshlrev_b32 v158, 16, v82
    v_and_b32 v159, 0xffff0000, v82
    v_pk_add_f32 v[166:167], v[166:167], v[158:159]
    v_lshlrev_b32 v158, 16, v83
    v_and_b32 v159, 0xffff0000, v83
    v_pk_add_f32 v[168:169], v[168:169], v[158:159]
    v_lshlrev_b32 v158, 16, v84
    v_and_b32 v159, 0xffff0000, v84
    v_pk_add_f32 v[162:163], v[162:163], v[158:159]
    v_lshlrev_b32 v158, 16, v85
    v_and_b32 v159, 0xffff0000, v85
    v_pk_add_f32 v[164:165], v[164:165], v[158:159]
    v_lshlrev_b32 v158, 16, v86
    v_and_b32 v159, 0xffff0000, v86
    s_add_u32 s77, s75, 143616
    buffer_store_dwordx4 v[148:151], v175, s[60:63], s77 offen sc1
    v_pk_add_f32 v[166:167], v[166:167], v[158:159]
    v_lshlrev_b32 v158, 16, v87
    v_and_b32 v159, 0xffff0000, v87
    v_pk_add_f32 v[168:169], v[168:169], v[158:159]
    v_lshlrev_b32 v158, 16, v88
    v_and_b32 v159, 0xffff0000, v88
    v_pk_add_f32 v[162:163], v[162:163], v[158:159]
    v_lshlrev_b32 v158, 16, v89
    v_and_b32 v159, 0xffff0000, v89
    v_pk_add_f32 v[164:165], v[164:165], v[158:159]
    v_lshlrev_b32 v158, 16, v90
    v_and_b32 v159, 0xffff0000, v90
    v_pk_add_f32 v[166:167], v[166:167], v[158:159]
    v_lshlrev_b32 v158, 16, v91
    v_and_b32 v159, 0xffff0000, v91
    v_pk_add_f32 v[168:169], v[168:169], v[158:159]
    s_add_u32 s77, s75, 147840
    buffer_store_dwordx4 v[152:155], v175, s[60:63], s77 offen sc1
    ds_write_b128 v170, v[162:165] offset:17408
    ds_write_b128 v170, v[166:169] offset:17424
    s_waitcnt lgkmcnt(0)
    s_barrier
    ds_read_b32 v162, v171 offset:17408
    ds_read_b32 v163, v171 offset:19584
    ds_read_b32 v164, v171 offset:21760
    ds_read_b32 v165, v171 offset:23936
    ds_read_b32 v166, v171 offset:26112
    ds_read_b32 v167, v171 offset:28288
    ds_read_b32 v168, v171 offset:30464
    ds_read_b32 v169, v171 offset:32640
    s_waitcnt lgkmcnt(0)
    v_add_f32 v162, v162, v163
    v_add_f32 v164, v164, v165
    v_add_f32 v166, v166, v167
    v_add_f32 v168, v168, v169
    v_add_f32 v162, v162, v164
    v_add_f32 v166, v166, v168
    v_add_f32 v162, v162, v166
    s_nop 1
    v_add_f32_dpp v162, v162, v162 quad_perm:[1,0,3,2] row_mask:0xf bank_mask:0xf
    s_nop 1
    v_add_f32_dpp v162, v162, v162 quad_perm:[2,3,0,1] row_mask:0xf bank_mask:0xf
    s_nop 1
    v_add_f32_dpp v162, v162, v162 row_half_mirror row_mask:0xf bank_mask:0xf
    v_mov_b32 v163, s68
    s_lshl_b32 s90, s74, 10
    s_add_u32 s90, s90, 49664
    s_mov_b32 exec_lo, 0x01010101
    s_mov_b32 exec_hi, 0x01010101
    buffer_store_dwordx2 v[162:163], v172, s[60:63], s90 offen sc1
    s_mov_b64 exec, -1
    s_waitcnt vmcnt(1)
    s_lshl_b32 s90, s69, 7
    s_lshl_b32 s91, s73, 2
    s_add_u32 s90, s90, s91
    s_lshl_b32 s90, s90, 3
    s_add_u32 s90, s90, 4096000
    v_lshlrev_b32 v176, 2, v1
    v_mov_b32 v177, s68
    s_mov_b32 exec_lo, 0xff
    s_mov_b32 exec_hi, 0
    buffer_store_dword v177, v176, s[60:63], s90 offen sc1
    s_mov_b64 exec, -1
    s_mov_b64 exec, -1
    s_cmp_lg_u32 s73, 0
    s_cbranch_scc1 L_16
    s_cmp_lg_u32 s69, 7
    s_cbranch_scc1 L_16
    v_and_b32 v8, 15, v1
    v_min_u32 v8, 13, v8
    v_lshrrev_b32 v9, 4, v1
    v_lshlrev_b32 v9, 10, v9
    v_lshl_add_u32 v8, v8, 3, v9
    v_lshlrev_b32 v8, 3, v8
    v_add_u32 v8, 3932160, v8
    s_sleep 0
    v_add_u32 v9, 32768, v8
    v_add_u32 v10, 65536, v8
    v_add_u32 v11, 98304, v8
    v_and_b32 v12, 31, v1
    v_lshlrev_b32 v12, 5, v12
    v_add_u32 v12, 4096000, v12
    buffer_load_dword v16, v8, s[60:63], 0 offen sc1
    buffer_load_dword v17, v9, s[60:63], 0 offen sc1
    buffer_load_dword v18, v10, s[60:63], 0 offen sc1
    buffer_load_dword v19, v11, s[60:63], 0 offen sc1
    buffer_load_dword v20, v12, s[60:63], 0 offen sc1
    s_waitcnt vmcnt(0)
    s_mov_b32 s94, 0
PAG_18:
    v_cmp_ne_u32 vcc, s68, v16
    v_cmp_ne_u32 s[90:91], s68, v17
    s_nop 0
    s_or_b64 vcc, vcc, s[90:91]
    v_cmp_ne_u32 s[90:91], s68, v18
    s_nop 0
    s_or_b64 vcc, vcc, s[90:91]
    v_cmp_ne_u32 s[90:91], s68, v19
    s_nop 0
    s_or_b64 vcc, vcc, s[90:91]
    v_cmp_ne_u32 s[90:91], s68, v20
    s_nop 0
    s_or_b64 vcc, vcc, s[90:91]
    s_cbranch_vccz POK_17
    s_add_u32 s94, s94, 1
    s_cmp_gt_u32 s94, 0x40000
    s_cbranch_scc1 POK_17
    s_sleep 32
    buffer_load_dword v16, v8, s[60:63], 0 offen sc1
    buffer_load_dword v17, v9, s[60:63], 0 offen sc1
    buffer_load_dword v18, v10, s[60:63], 0 offen sc1
    buffer_load_dword v19, v11, s[60:63], 0 offen sc1
    buffer_load_dword v20, v12, s[60:63], 0 offen sc1
    s_waitcnt vmcnt(0)
    s_branch PAG_18
POK_17:
    s_mov_b64 exec, 1
    buffer_store_dword v177, v176, s[60:63], 0 offen sc1
L_16:
    s_endpgm
L_EXIT:
    s_endpgm
L_CODE_END:
.section .rodata,"a"
.p2align 6
.amdhsa_kernel parallel_sum__ssm_conv_s4__glu_gated_glu__prompt_kernel
  .amdhsa_next_free_vgpr 256
  .amdhsa_next_free_sgpr 102
  .amdhsa_accum_offset 256
  .amdhsa_group_segment_fixed_size 0
  .amdhsa_kernarg_size 128
  .amdhsa_user_sgpr_count 2
  .amdhsa_user_sgpr_kernarg_segment_ptr 1
  .amdhsa_system_sgpr_workgroup_id_x 1
.end_amdhsa_kernel
```
